```python
import torch

def _softmax(x, axis=-1):
    return torch.softmax(x, dim=axis)
def _gelu(x):
    return torch.nn.functional.gelu(x, approximate="tanh")
def _silu(x):
    return torch.nn.functional.silu(x)
def _sigmoid(x):
    return torch.sigmoid(x)
def _layernorm(x, axis=-1, eps=1e-5):
    m = x.mean(dim=axis, keepdim=True)
    v = x.var(dim=axis, keepdim=True, unbiased=False)
    return (x - m) / torch.sqrt(v + eps)
def _scatter_add(tgt, idx, src, axis=0):
    return tgt.clone().index_add_(axis, idx, src)
def _segment_sum(src, seg, n):
    out = torch.zeros((n,) + src.shape[1:], dtype=src.dtype)
    return out.index_add_(0, seg, src)
def _pad(x, pw):
    flat = tuple(v for pair in reversed(pw) for v in pair)
    return torch.nn.functional.pad(x, flat)

kernel_name = 'gated_mix__gqa_block_cached__geglu_ffn__decode'

def setup_inputs():

    _w = (lambda a: (lambda t: t.to(torch.bfloat16) if t.is_floating_point() else t)(torch.as_tensor(a)))
    def _A_setup():
        B, Sq, D = 8, 1, 512
        Hq, Hkv, Sk, Dh = 32, 8, 8192, 128
        assert Hq % Hkv == 0, (Hq, Hkv)
        return {
            "x": _w((lambda *s: torch.randn(*s, dtype=torch.bfloat16) * 0.05)(B, Sq, D)),
            "k_cache": _w((lambda *s: torch.randn(*s, dtype=torch.bfloat16) * 6.4)(B, Hkv, Sk, Dh)),
            "v_cache": _w((lambda *s: torch.randn(*s, dtype=torch.bfloat16) * 0.2)(B, Hkv, Sk, Dh)),
            "wq": _w((lambda *s: torch.randn(*s, dtype=torch.bfloat16) * 6.4)(D, Hq * Dh) * (D ** -0.5)),
            "wo": _w((lambda *s: torch.randn(*s, dtype=torch.bfloat16) * 0.2)(Hq * Dh, D) * ((Hq * Dh) ** -0.5)),
        }
    _A_in = _A_setup()

    def _B_setup():
        B, S, D, F = 8, 1, 512, 1792
        return {
            "x": _w((lambda *s: torch.randn(*s, dtype=torch.bfloat16) * 0.05)(B, S, D)),
            "w_gate": _w((lambda *s: torch.randn(*s, dtype=torch.bfloat16) * 0.05)(D, F)),
            "w_up": _w((lambda *s: torch.randn(*s, dtype=torch.bfloat16) * 0.05)(D, F)),
            "w_down": _w((lambda *s: torch.randn(*s, dtype=torch.bfloat16) * 0.05)(F, D)),
        }
    _B_in = _B_setup()

    return {
        "A_x": _A_in["x"],
        "A_k_cache": _A_in["k_cache"],
        "A_v_cache": _A_in["v_cache"],
        "A_wq": _A_in["wq"],
        "A_wo": _A_in["wo"],
        "B_x": _B_in["x"],
        "B_w_gate": _B_in["w_gate"],
        "B_w_up": _B_in["w_up"],
        "B_w_down": _B_in["w_down"],
        "gate_w": _w((lambda *s: torch.randn(*s, dtype=torch.bfloat16) * 0.05)(512) * 16.0),
    }

def reference(A_x, A_k_cache, A_v_cache, A_wq, A_wo, B_x, B_w_gate, B_w_up, B_w_down, gate_w):
    def _A_ref(x, k_cache, v_cache, wq, wo):
        B, Sq, D = x.shape
        Hq, Dh = 32, 128
        Hkv = k_cache.shape[1]
        rep = Hq // Hkv
        q = (lambda x, *d: x.permute(*d))((x @ wq).reshape(B, Sq, Hq, Dh), 0, 2, 1, 3)
        k = (lambda x, n, axis: torch.repeat_interleave(x, n, dim=axis))(k_cache, rep, axis=1)
        v = (lambda x, n, axis: torch.repeat_interleave(x, n, dim=axis))(v_cache, rep, axis=1)
        scores = torch.einsum("bhqd,bhkd->bhqk", q, k) * (Dh ** -0.5)
        p = _softmax(scores, axis=-1)
        o = torch.einsum("bhqk,bhkd->bhqd", p, v)
        return (lambda x, *d: x.permute(*d))(o, 0, 2, 1, 3).reshape(B, Sq, Hq * Dh) @ wo

    def _B_ref(x, w_gate, w_up, w_down):
        return (_gelu(x @ w_gate) * (x @ w_up)) @ w_down

    x = A_x
    g = _sigmoid((x * gate_w).sum(-1, keepdims=True))
    a = _A_ref(x, A_k_cache, A_v_cache, A_wq, A_wo)
    b = _B_ref(x, B_w_gate, B_w_up, B_w_down)
    return g * a + (1 - g) * b
```

```asm
; @launch grid=(256,1,1) block=(640,1,1) lds=163840
.amdgcn_target "amdgcn-amd-amdhsa--gfx950"
.text
.globl gated_mix__gqa_block_cached__geglu_ffn__decode_kernel
.p2align 8
.type gated_mix__gqa_block_cached__geglu_ffn__decode_kernel,@function
gated_mix__gqa_block_cached__geglu_ffn__decode_kernel:
  s_cmp_ge_u32 s2, 256
  s_cbranch_scc1 L_end
  s_load_dwordx16 s[32:47], s[0:1], 0
  s_load_dwordx8 s[48:55], s[0:1], 64
  s_load_dwordx2 s[56:57], s[0:1], 96
  v_lshrrev_b32 v1, 6, v0
  v_and_b32 v0, 63, v0
  s_and_b32 s17, s2, 7
  v_readfirstlane_b32 s3, v1
  s_mov_b32 s16, s2
  s_lshr_b32 s18, s16, 3
  s_and_b32 s19, s18, 7
  s_lshr_b32 s20, s18, 3
  s_xor_b32 s20, s20, 0
  s_cmp_lt_u32 s3, 8
  s_cbranch_scc0 L_help
  v_and_b32 v22, 15, v0
  v_lshrrev_b32 v23, 4, v0
  s_mul_i32 s24, s3, 12288
  v_add_u32 v19, 0, v23
  v_xor_b32 v19, v19, v22
  v_lshlrev_b32 v19, 4, v19
  v_lshl_add_u32 v1, v23, 8, v19
  v_lshl_add_u32 v7, v22, 8, v19
  v_add_u32 v19, 4, v23
  v_xor_b32 v19, v19, v22
  v_lshlrev_b32 v19, 4, v19
  v_lshl_add_u32 v2, v23, 8, v19
  v_lshl_add_u32 v8, v22, 8, v19
  v_add_u32 v19, 8, v23
  v_xor_b32 v19, v19, v22
  v_lshlrev_b32 v19, 4, v19
  v_lshl_add_u32 v3, v23, 8, v19
  v_lshl_add_u32 v9, v22, 8, v19
  v_add_u32 v19, 12, v23
  v_xor_b32 v19, v19, v22
  v_lshlrev_b32 v19, 4, v19
  v_lshl_add_u32 v4, v23, 8, v19
  v_lshl_add_u32 v10, v22, 8, v19
  s_lshl_b32 s30, s20, 4
  s_add_u32 s30, s30, s19
  s_lshr_b32 s26, s17, 2
  s_lshl3_add_u32 s30, s26, s30
  s_and_b32 s22, s17, 3
  s_lshl_b32 s21, s30, 21
  s_lshl_b32 s22, s22, 3
  s_add_u32 s22, s22, s3
  s_mul_i32 s77, s20, 256
  s_mul_i32 s26, s26, 128
  s_add_u32 s77, s77, s26
  s_mul_i32 s25, s19, 8
  s_add_u32 s77, s77, s25
  s_add_u32 s22, s22, s77
  s_and_b32 s26, s22, 511
  s_lshl_b32 s26, s26, 12
  s_add_u32 s26, s26, s21
  s_add_u32 m0, s24, 8192
  s_waitcnt lgkmcnt(0)
  s_mov_b32 s4, s34
  s_mov_b32 s5, s35
  s_mov_b32 s6, 0x8000000
  s_mov_b32 s7, 0x00020000
  buffer_load_dwordx4 v1, s[4:7], s26 offen offset:0 nt lds
  buffer_load_dwordx4 v2, s[4:7], s26 offen offset:1024 nt lds
  buffer_load_dwordx4 v3, s[4:7], s26 offen offset:2048 nt lds
  buffer_load_dwordx4 v4, s[4:7], s26 offen offset:3072 nt lds
  s_branch L_stream
L_help:
  v_and_b32 v10, 15, v0
  v_lshrrev_b32 v11, 4, v0
  v_lshlrev_b32 v2, 4, v11
  v_lshl_add_u32 v2, v10, 10, v2
  v_lshrrev_b32 v3, 1, v0
  v_and_b32 v4, 1, v0
  v_lshlrev_b32 v4, 4, v4
  v_mov_b32 v13, 0
  s_cmp_eq_u32 s3, 9
  s_cbranch_scc1 L_hb
  s_setprio 3
  s_memrealtime s[74:75]
  s_mov_b64 s[72:73], 1
  v_mov_b32 v15, 252
  v_lshlrev_b32 v3, 4, v0
  s_waitcnt lgkmcnt(0)
  s_mov_b32 s68, s54
  s_mov_b32 s69, s55
  s_mov_b32 s70, 0x100
  s_mov_b32 s71, 0x00020000
  s_cmp_ge_u32 s16, 8
  s_cbranch_scc1 L_nononce
  s_or_b32 s74, s74, 1
  v_mov_b32 v12, s74
  s_mov_b64 exec, s[72:73]
  buffer_atomic_cmpswap v[12:13], v15, s[68:71], 0 offen sc1
  s_mov_b64 exec, -1
L_nononce:
  s_mov_b32 s60, s38
  s_mov_b32 s61, s39
  s_mov_b32 s62, 0x400000
  s_mov_b32 s63, 0x00020000
  s_mov_b32 s64, s32
  s_mov_b32 s65, s33
  s_mov_b32 s66, 0x2000
  s_mov_b32 s67, 0x00020000
  v_xor_b32 v16, 0, v3
  v_xor_b32 v17, 16, v3
  v_xor_b32 v18, 32, v3
  v_xor_b32 v19, 48, v3
  v_xor_b32 v20, 64, v3
  v_xor_b32 v21, 80, v3
  v_xor_b32 v22, 96, v3
  v_xor_b32 v23, 112, v3
  s_mov_b32 m0, 155648
  s_movk_i32 s25, 0
  buffer_load_dwordx4 v16, s[64:67], s25 offen lds
  s_mov_b32 m0, 156672
  s_movk_i32 s25, 1024
  buffer_load_dwordx4 v17, s[64:67], s25 offen lds
  s_mov_b32 m0, 157696
  s_movk_i32 s25, 2048
  buffer_load_dwordx4 v18, s[64:67], s25 offen lds
  s_mov_b32 m0, 158720
  s_movk_i32 s25, 3072
  buffer_load_dwordx4 v19, s[64:67], s25 offen lds
  s_mov_b32 m0, 159744
  s_movk_i32 s25, 4096
  buffer_load_dwordx4 v20, s[64:67], s25 offen lds
  s_mov_b32 m0, 160768
  s_movk_i32 s25, 5120
  buffer_load_dwordx4 v21, s[64:67], s25 offen lds
  s_mov_b32 m0, 161792
  s_movk_i32 s25, 6144
  buffer_load_dwordx4 v22, s[64:67], s25 offen lds
  s_mov_b32 m0, 162816
  s_movk_i32 s25, 7168
  buffer_load_dwordx4 v23, s[64:67], s25 offen lds
  s_mov_b32 s25, 0
  s_mov_b32 s21, -1
  s_lshr_b32 s27, s18, 1
  v_lshrrev_b32 v40, 2, v0
  v_and_b32 v41, 3, v0
  v_lshlrev_b32 v41, 4, v41
  s_bitcmp1_b32 s18, 0
  s_cbranch_scc1 L_fhg
  s_lshl_b32 s29, s17, 4
  s_add_u32 s29, s29, s27
  s_lshl_b32 s21, s29, 10
  s_add_u32 s21, s21, 0
  s_lshl_b32 s29, s29, 6
  v_lshl_add_u32 v40, v40, 13, v41
  s_mov_b32 s28, 131072
  s_branch L_fhl
L_fhg:
  s_cmp_ge_u32 s27, 14
  s_cbranch_scc1 L_fhd
  s_and_b32 s29, s17, 3
  s_mul_i32 s29, s29, 14
  s_add_u32 s29, s29, s27
  s_lshl_b32 s21, s29, 10
  s_lshr_b32 s28, s17, 2
  s_lshl_b32 s28, s28, 16
  s_add_u32 s21, s21, s28
  s_add_u32 s21, s21, 131072
  s_lshl_b32 s29, s29, 6
  v_mul_u32_u24 v40, 3584, v40
  v_add_u32 v40, v40, v41
  s_mov_b32 s28, 57344
  s_cmp_lt_u32 s17, 4
  s_cselect_b32 s60, s44, s46
  s_cselect_b32 s61, s45, s47
  s_mov_b32 s62, 1835008
L_fhl:
  s_mov_b32 m0, 114688
  s_nop 0
  buffer_load_dwordx4 v40, s[60:63], s29 offen nt lds
  s_mov_b32 m0, 115712
  s_add_u32 s29, s29, s28
  buffer_load_dwordx4 v40, s[60:63], s29 offen nt lds
  s_mov_b32 m0, 116736
  s_add_u32 s29, s29, s28
  buffer_load_dwordx4 v40, s[60:63], s29 offen nt lds
  s_mov_b32 m0, 117760
  s_add_u32 s29, s29, s28
  buffer_load_dwordx4 v40, s[60:63], s29 offen nt lds
  s_mov_b32 m0, 118784
  s_add_u32 s29, s29, s28
  buffer_load_dwordx4 v40, s[60:63], s29 offen nt lds
  s_mov_b32 m0, 119808
  s_add_u32 s29, s29, s28
  buffer_load_dwordx4 v40, s[60:63], s29 offen nt lds
  s_mov_b32 m0, 120832
  s_add_u32 s29, s29, s28
  buffer_load_dwordx4 v40, s[60:63], s29 offen nt lds
  s_mov_b32 m0, 121856
  s_add_u32 s29, s29, s28
  buffer_load_dwordx4 v40, s[60:63], s29 offen nt lds
  s_mov_b32 m0, 122880
  s_add_u32 s29, s29, s28
  buffer_load_dwordx4 v40, s[60:63], s29 offen nt lds
  s_mov_b32 m0, 123904
  s_add_u32 s29, s29, s28
  buffer_load_dwordx4 v40, s[60:63], s29 offen nt lds
  s_mov_b32 m0, 124928
  s_add_u32 s29, s29, s28
  buffer_load_dwordx4 v40, s[60:63], s29 offen nt lds
  s_mov_b32 m0, 125952
  s_add_u32 s29, s29, s28
  buffer_load_dwordx4 v40, s[60:63], s29 offen nt lds
  s_mov_b32 m0, 126976
  s_add_u32 s29, s29, s28
  buffer_load_dwordx4 v40, s[60:63], s29 offen nt lds
  s_mov_b32 m0, 128000
  s_add_u32 s29, s29, s28
  buffer_load_dwordx4 v40, s[60:63], s29 offen nt lds
  s_mov_b32 m0, 129024
  s_add_u32 s29, s29, s28
  buffer_load_dwordx4 v40, s[60:63], s29 offen nt lds
  s_mov_b32 m0, 130048
  s_add_u32 s29, s29, s28
  buffer_load_dwordx4 v40, s[60:63], s29 offen nt lds
  s_mov_b32 m0, 131072
  s_add_u32 s29, s29, s28
  buffer_load_dwordx4 v40, s[60:63], s29 offen nt lds
  s_mov_b32 m0, 132096
  s_add_u32 s29, s29, s28
  buffer_load_dwordx4 v40, s[60:63], s29 offen nt lds
  s_mov_b32 m0, 133120
  s_add_u32 s29, s29, s28
  buffer_load_dwordx4 v40, s[60:63], s29 offen nt lds
  s_mov_b32 m0, 134144
  s_add_u32 s29, s29, s28
  buffer_load_dwordx4 v40, s[60:63], s29 offen nt lds
  s_mov_b32 m0, 135168
  s_add_u32 s29, s29, s28
  buffer_load_dwordx4 v40, s[60:63], s29 offen nt lds
  s_mov_b32 m0, 136192
  s_add_u32 s29, s29, s28
  buffer_load_dwordx4 v40, s[60:63], s29 offen nt lds
  s_mov_b32 m0, 137216
  s_add_u32 s29, s29, s28
  buffer_load_dwordx4 v40, s[60:63], s29 offen nt lds
  s_mov_b32 m0, 138240
  s_add_u32 s29, s29, s28
  buffer_load_dwordx4 v40, s[60:63], s29 offen nt lds
  s_mov_b32 m0, 139264
  s_add_u32 s29, s29, s28
  buffer_load_dwordx4 v40, s[60:63], s29 offen nt lds
  s_mov_b32 m0, 140288
  s_add_u32 s29, s29, s28
  buffer_load_dwordx4 v40, s[60:63], s29 offen nt lds
  s_mov_b32 m0, 141312
  s_add_u32 s29, s29, s28
  buffer_load_dwordx4 v40, s[60:63], s29 offen nt lds
  s_mov_b32 m0, 142336
  s_add_u32 s29, s29, s28
  buffer_load_dwordx4 v40, s[60:63], s29 offen nt lds
  s_mov_b32 m0, 143360
  s_add_u32 s29, s29, s28
  buffer_load_dwordx4 v40, s[60:63], s29 offen nt lds
  s_mov_b32 m0, 144384
  s_add_u32 s29, s29, s28
  buffer_load_dwordx4 v40, s[60:63], s29 offen nt lds
  s_mov_b32 m0, 145408
  s_add_u32 s29, s29, s28
  buffer_load_dwordx4 v40, s[60:63], s29 offen nt lds
  s_mov_b32 m0, 146432
  s_add_u32 s29, s29, s28
  buffer_load_dwordx4 v40, s[60:63], s29 offen nt lds
L_fhd:
  s_mov_b32 s12, s56
  s_mov_b32 s13, s57
  s_mov_b32 s14, 0x500000
  s_mov_b32 s15, 0x00020000
  s_lshl3_add_u32 s77, s20, s19
  s_mul_i32 s77, s77, 4352
  s_add_u32 s77, s77, 4718592
  s_lshr_b32 s25, s17, 2
  s_lshl_b32 s25, s25, 11
  s_add_u32 s77, s77, s25
  s_lshl_b32 s25, s18, 2
  s_add_u32 s25, s25, s17
  s_mul_i32 s25, s25, 4352
  s_add_u32 s25, s25, 4718592
  s_and_b32 s26, s18, 25
  s_cbranch_scc1 L_nocnt
  v_mov_b32 v14, 8
  s_mov_b64 exec, s[72:73]
  buffer_store_dword v14, v13, s[12:15], s25 offen sc1
  buffer_store_dword v14, v13, s[12:15], s25 offen offset:2048 sc1
  s_mov_b64 exec, -1
L_nocnt:
  buffer_load_dword v12, v15, s[68:71], 0 offen sc1
  v_mov_b32 v4, -1
  v_mov_b32 v5, -1
  v_mov_b32 v6, -1
  v_mov_b32 v7, -1
  v_add_u32 v1, 152576, v3
  ds_write_b128 v1, v[4:7]
  ds_write_b128 v1, v[4:7] offset:1024
  ds_write_b128 v1, v[4:7] offset:2048
  v_mov_b32 v2, 149504
  v_mov_b32 v4, 0
  v_mov_b32 v5, 0
  v_mov_b32 v6, 0
  v_mov_b32 v7, 0
  ds_write_b128 v2, v[4:7] offset:128
  ds_write_b128 v2, v[4:7] offset:144
  v_lshl_add_u32 v35, v0, 16, v0
  s_and_b32 s27, s17, 3
  s_mul_i32 s25, s27, 29
  s_add_u32 s26, s25, 32864
  v_add_u32 v4, s26, v35
  v_lshrrev_b32 v5, 2, v0
  v_mul_u32_u24 v5, 12, v5
  s_lshl_b32 s26, s27, 2
  s_add_u32 s26, s26, 32768
  v_add3_u32 v5, v5, s26, v35
  v_cmp_gt_u32 vcc, 32, v0
  s_nop 1
  v_cndmask_b32 v4, v4, v5, vcc
  v_lshlrev_b32 v1, 2, v0
  v_add_u32 v5, 4, v1
  v_cmp_gt_u32 vcc, 5, v0
  s_nop 1
  v_cndmask_b32 v5, v5, v1, vcc
  v_add_u32 v5, 152696, v5
  v_mov_b32 v66, v5
  v_mov_b32 v67, v4
  v_mov_b32 v4, 512
  v_add_u32 v5, 152716, v1
  s_mov_b64 exec, 1
  ds_write_b32 v5, v4
  s_mov_b64 exec, -1
  s_add_u32 s25, s25, 2097280
  v_add_u32 v4, s25, v35
  v_lshlrev_b32 v1, 2, v0
  v_add_u32 v1, 152576, v1
  v_subrev_u32 v5, 65537, v4
  v_cmp_le_u32 vcc, 0, v0
  v_mov_b32 v6, 512
  s_nop 0
  v_cndmask_b32 v4, v4, v6, vcc
  v_cmp_le_u32 vcc, 1, v0
  s_nop 1
  v_cndmask_b32 v4, v4, v5, vcc
  v_cmp_gt_u32 vcc, 1, v0
  v_mov_b32 v64, v1
  v_mov_b32 v65, v4
  s_mov_b64 exec, vcc
  ds_write_b32 v1, v4
  s_mov_b64 exec, -1
  v_lshrrev_b32 v8, 2, v10
  v_lshl_add_u32 v8, v11, 3, v8
  v_lshlrev_b32 v9, 6, v8
  v_and_b32 v8, 3, v0
  v_lshl_add_u32 v9, v8, 3, v9
  v_add_u32 v9, 114688, v9
  v_lshrrev_b32 v60, 3, v0
  v_lshl_add_u32 v60, v8, 4, v60
  v_and_b32 v8, 4, v0
  v_lshl_add_u32 v60, v8, 1, v60
  v_lshlrev_b32 v60, 2, v60
  s_mov_b32 s76, 65536
  s_waitcnt lgkmcnt(0)
  s_barrier
  s_cmp_eq_u32 s21, -1
  s_cbranch_scc1 L_nogv
  s_waitcnt vmcnt(33)
  v_and_b32 v56, 7, v10
  v_xor_b32 v57, v56, v11
  v_lshlrev_b32 v57, 4, v57
  v_lshl_add_u32 v56, v56, 10, v57
  v_add_u32 v56, 155648, v56
  v_xor_b32 v57, 64, v56
  ds_read_b128 v[100:103], v56 offset:0
  ds_read_b128 v[104:107], v57 offset:0
  ds_read_b128 v[108:111], v56 offset:128
  ds_read_b128 v[112:115], v57 offset:128
  ds_read_b128 v[116:119], v56 offset:256
  ds_read_b128 v[120:123], v57 offset:256
  ds_read_b128 v[124:127], v56 offset:384
  ds_read_b128 v[128:131], v57 offset:384
  ds_read_b128 v[132:135], v56 offset:512
  ds_read_b128 v[136:139], v57 offset:512
  ds_read_b128 v[140:143], v56 offset:640
  ds_read_b128 v[144:147], v57 offset:640
  ds_read_b128 v[148:151], v56 offset:768
  ds_read_b128 v[152:155], v57 offset:768
  ds_read_b128 v[156:159], v56 offset:896
  ds_read_b128 v[160:163], v57 offset:896
  s_waitcnt vmcnt(25)
  ds_read_b64_tr_b16 v[16:17], v9 offset:0
  ds_read_b64_tr_b16 v[18:19], v9 offset:256
  ds_read_b64_tr_b16 v[20:21], v9 offset:32
  ds_read_b64_tr_b16 v[22:23], v9 offset:288
  ds_read_b64_tr_b16 v[24:25], v9 offset:2048
  ds_read_b64_tr_b16 v[26:27], v9 offset:2304
  ds_read_b64_tr_b16 v[28:29], v9 offset:2080
  ds_read_b64_tr_b16 v[30:31], v9 offset:2336
  ds_read_b64_tr_b16 v[32:33], v9 offset:4096
  ds_read_b64_tr_b16 v[34:35], v9 offset:4352
  ds_read_b64_tr_b16 v[36:37], v9 offset:4128
  ds_read_b64_tr_b16 v[38:39], v9 offset:4384
  ds_read_b64_tr_b16 v[40:41], v9 offset:6144
  ds_read_b64_tr_b16 v[42:43], v9 offset:6400
  ds_read_b64_tr_b16 v[44:45], v9 offset:6176
  ds_read_b64_tr_b16 v[46:47], v9 offset:6432
  s_waitcnt lgkmcnt(8)
  v_mfma_f32_16x16x32_bf16 v[48:51], v[16:19], v[100:103], 0
  v_mfma_f32_16x16x32_bf16 v[52:55], v[20:23], v[100:103], 0
  v_mfma_f32_16x16x32_bf16 v[48:51], v[24:27], v[104:107], v[48:51]
  v_mfma_f32_16x16x32_bf16 v[52:55], v[28:31], v[104:107], v[52:55]
  s_waitcnt vmcnt(17)
  ds_read_b64_tr_b16 v[16:17], v9 offset:8192
  ds_read_b64_tr_b16 v[18:19], v9 offset:8448
  ds_read_b64_tr_b16 v[20:21], v9 offset:8224
  ds_read_b64_tr_b16 v[22:23], v9 offset:8480
  ds_read_b64_tr_b16 v[24:25], v9 offset:10240
  ds_read_b64_tr_b16 v[26:27], v9 offset:10496
  ds_read_b64_tr_b16 v[28:29], v9 offset:10272
  ds_read_b64_tr_b16 v[30:31], v9 offset:10528
  s_waitcnt lgkmcnt(8)
  v_mfma_f32_16x16x32_bf16 v[48:51], v[32:35], v[108:111], v[48:51]
  v_mfma_f32_16x16x32_bf16 v[52:55], v[36:39], v[108:111], v[52:55]
  v_mfma_f32_16x16x32_bf16 v[48:51], v[40:43], v[112:115], v[48:51]
  v_mfma_f32_16x16x32_bf16 v[52:55], v[44:47], v[112:115], v[52:55]
  ds_read_b64_tr_b16 v[32:33], v9 offset:12288
  ds_read_b64_tr_b16 v[34:35], v9 offset:12544
  ds_read_b64_tr_b16 v[36:37], v9 offset:12320
  ds_read_b64_tr_b16 v[38:39], v9 offset:12576
  ds_read_b64_tr_b16 v[40:41], v9 offset:14336
  ds_read_b64_tr_b16 v[42:43], v9 offset:14592
  ds_read_b64_tr_b16 v[44:45], v9 offset:14368
  ds_read_b64_tr_b16 v[46:47], v9 offset:14624
  s_waitcnt lgkmcnt(8)
  v_mfma_f32_16x16x32_bf16 v[48:51], v[16:19], v[116:119], v[48:51]
  v_mfma_f32_16x16x32_bf16 v[52:55], v[20:23], v[116:119], v[52:55]
  v_mfma_f32_16x16x32_bf16 v[48:51], v[24:27], v[120:123], v[48:51]
  v_mfma_f32_16x16x32_bf16 v[52:55], v[28:31], v[120:123], v[52:55]
  s_waitcnt vmcnt(9)
  ds_read_b64_tr_b16 v[16:17], v9 offset:16384
  ds_read_b64_tr_b16 v[18:19], v9 offset:16640
  ds_read_b64_tr_b16 v[20:21], v9 offset:16416
  ds_read_b64_tr_b16 v[22:23], v9 offset:16672
  ds_read_b64_tr_b16 v[24:25], v9 offset:18432
  ds_read_b64_tr_b16 v[26:27], v9 offset:18688
  ds_read_b64_tr_b16 v[28:29], v9 offset:18464
  ds_read_b64_tr_b16 v[30:31], v9 offset:18720
  s_waitcnt lgkmcnt(8)
  v_mfma_f32_16x16x32_bf16 v[48:51], v[32:35], v[124:127], v[48:51]
  v_mfma_f32_16x16x32_bf16 v[52:55], v[36:39], v[124:127], v[52:55]
  v_mfma_f32_16x16x32_bf16 v[48:51], v[40:43], v[128:131], v[48:51]
  v_mfma_f32_16x16x32_bf16 v[52:55], v[44:47], v[128:131], v[52:55]
  ds_read_b64_tr_b16 v[32:33], v9 offset:20480
  ds_read_b64_tr_b16 v[34:35], v9 offset:20736
  ds_read_b64_tr_b16 v[36:37], v9 offset:20512
  ds_read_b64_tr_b16 v[38:39], v9 offset:20768
  ds_read_b64_tr_b16 v[40:41], v9 offset:22528
  ds_read_b64_tr_b16 v[42:43], v9 offset:22784
  ds_read_b64_tr_b16 v[44:45], v9 offset:22560
  ds_read_b64_tr_b16 v[46:47], v9 offset:22816
  s_waitcnt lgkmcnt(8)
  v_mfma_f32_16x16x32_bf16 v[48:51], v[16:19], v[132:135], v[48:51]
  v_mfma_f32_16x16x32_bf16 v[52:55], v[20:23], v[132:135], v[52:55]
  v_mfma_f32_16x16x32_bf16 v[48:51], v[24:27], v[136:139], v[48:51]
  v_mfma_f32_16x16x32_bf16 v[52:55], v[28:31], v[136:139], v[52:55]
  s_waitcnt vmcnt(1)
  ds_read_b64_tr_b16 v[16:17], v9 offset:24576
  ds_read_b64_tr_b16 v[18:19], v9 offset:24832
  ds_read_b64_tr_b16 v[20:21], v9 offset:24608
  ds_read_b64_tr_b16 v[22:23], v9 offset:24864
  ds_read_b64_tr_b16 v[24:25], v9 offset:26624
  ds_read_b64_tr_b16 v[26:27], v9 offset:26880
  ds_read_b64_tr_b16 v[28:29], v9 offset:26656
  ds_read_b64_tr_b16 v[30:31], v9 offset:26912
  s_waitcnt lgkmcnt(8)
  v_mfma_f32_16x16x32_bf16 v[48:51], v[32:35], v[140:143], v[48:51]
  v_mfma_f32_16x16x32_bf16 v[52:55], v[36:39], v[140:143], v[52:55]
  v_mfma_f32_16x16x32_bf16 v[48:51], v[40:43], v[144:147], v[48:51]
  v_mfma_f32_16x16x32_bf16 v[52:55], v[44:47], v[144:147], v[52:55]
  ds_read_b64_tr_b16 v[32:33], v9 offset:28672
  ds_read_b64_tr_b16 v[34:35], v9 offset:28928
  ds_read_b64_tr_b16 v[36:37], v9 offset:28704
  ds_read_b64_tr_b16 v[38:39], v9 offset:28960
  ds_read_b64_tr_b16 v[40:41], v9 offset:30720
  ds_read_b64_tr_b16 v[42:43], v9 offset:30976
  ds_read_b64_tr_b16 v[44:45], v9 offset:30752
  ds_read_b64_tr_b16 v[46:47], v9 offset:31008
  s_waitcnt lgkmcnt(8)
  v_mfma_f32_16x16x32_bf16 v[48:51], v[16:19], v[148:151], v[48:51]
  v_mfma_f32_16x16x32_bf16 v[52:55], v[20:23], v[148:151], v[52:55]
  v_mfma_f32_16x16x32_bf16 v[48:51], v[24:27], v[152:155], v[48:51]
  v_mfma_f32_16x16x32_bf16 v[52:55], v[28:31], v[152:155], v[52:55]
  s_waitcnt lgkmcnt(0)
  v_mfma_f32_16x16x32_bf16 v[48:51], v[32:35], v[156:159], v[48:51]
  v_mfma_f32_16x16x32_bf16 v[52:55], v[36:39], v[156:159], v[52:55]
  v_mfma_f32_16x16x32_bf16 v[48:51], v[40:43], v[160:163], v[48:51]
  v_mfma_f32_16x16x32_bf16 v[52:55], v[44:47], v[160:163], v[52:55]
  s_nop 6
  v_cvt_pk_bf16_f32 v4, v48, v49
  v_cvt_pk_bf16_f32 v6, v50, v51
  v_cvt_pk_bf16_f32 v56, v52, v53
  v_cvt_pk_bf16_f32 v57, v54, v55
  s_nop 0
  v_mov_b32_dpp v4, v56 row_ror:8 row_mask:0xf bank_mask:0xc
  v_mov_b32_dpp v6, v57 row_ror:8 row_mask:0xf bank_mask:0xc
  ds_bpermute_b32 v4, v60, v4
  ds_bpermute_b32 v6, v60, v6
L_nogv:
  s_waitcnt vmcnt(0)
L_np:
  v_readfirstlane_b32 s74, v12
  s_sub_u32 s76, s76, 1
  s_cmp_eq_u32 s76, 0
  s_cbranch_scc1 L_np_done
  s_cmp_lg_u32 s74, 0
  s_cbranch_scc1 L_np_done
  buffer_load_dword v12, v15, s[68:71], 0 offen sc1
  s_waitcnt vmcnt(0)
  s_branch L_np
L_np_done:
  s_cmp_lg_u32 s16, 0
  s_cbranch_scc1 L_nfi
  v_mov_b32 v5, s74
  v_mul_u32_u24 v7, 4352, v0
  s_mov_b32 s25, 5046272
  s_mov_b64 exec, 0xffff
  buffer_store_dword v5, v7, s[12:15], s25 offen sc1
  s_mov_b64 exec, -1
L_nfi:
  v_mov_b32 v5, s74
  v_mov_b32 v7, s74
  v_mov_b32 v8, 1
  ds_write_b32 v2, v5 offset:96
  ds_write_b32 v2, v8 offset:136
  s_cmp_eq_u32 s21, -1
  s_cbranch_scc1 L_nopub
  s_waitcnt lgkmcnt(0)
  buffer_store_dwordx4 v[4:7], v3, s[12:15], s21 offen sc1
L_nopub:
  v_mov_b32 v16, 0x7f817f81
  v_mov_b32 v17, 0x7f817f81
  v_mov_b32 v18, 0x7f817f81
  v_mov_b32 v19, 0x7f817f81
  v_add_u32 v1, 114688, v3
  ds_write_b128 v1, v[16:19] offset:0
  ds_write_b128 v1, v[16:19] offset:1024
  ds_write_b128 v1, v[16:19] offset:2048
  ds_write_b128 v1, v[16:19] offset:3072
  ds_write_b128 v1, v[16:19] offset:4096
  ds_write_b128 v1, v[16:19] offset:5120
  ds_write_b128 v1, v[16:19] offset:6144
  ds_write_b128 v1, v[16:19] offset:7168
  s_lshl_b32 s25, s20, 15
  s_lshl_b32 s26, s19, 11
  s_add_u32 s25, s25, s26
  s_add_u32 s25, s25, 0
  s_add_u32 s26, s25, 16384
  s_lshl_b32 s27, s18, 6
  s_lshl_b32 s25, s19, 14
  s_lshl_b32 s26, s20, 8
  s_add_u32 s25, s25, s26
  s_lshr_b32 s26, s17, 2
  s_lshl_b32 s26, s26, 7
  s_add_u32 s25, s25, s26
  s_add_u32 s25, s25, 0
  s_add_u32 s26, s25, 8192
  v_and_b32 v14, 7, v0
  v_lshlrev_b32 v14, 4, v14
  v_lshrrev_b32 v1, 3, v0
  v_lshl_add_u32 v14, v1, 10, v14
  v_lshlrev_b32 v1, 3, v0
  v_add_u32 v1, 147456, v1
  s_add_u32 s27, s27, 0
  s_mov_b32 s76, 65536
  s_sleep 80
L_qpoll:
  buffer_load_dwordx4 v[16:19], v14, s[12:15], s25 offen sc1
  buffer_load_dwordx4 v[20:23], v14, s[12:15], s26 offen sc1
  s_waitcnt vmcnt(0)
  v_cmp_ne_u32 vcc, s74, v17
  v_cmp_ne_u32 s[78:79], s74, v19
  s_or_b64 vcc, vcc, s[78:79]
  v_cmp_ne_u32 s[78:79], s74, v21
  s_or_b64 vcc, vcc, s[78:79]
  v_cmp_ne_u32 s[78:79], s74, v23
  s_or_b64 vcc, vcc, s[78:79]
  s_sub_u32 s76, s76, 1
  s_cmp_eq_u32 s76, 0
  s_cbranch_scc1 L_qdone
  s_cmp_eq_u64 vcc, 0
  s_cbranch_scc1 L_qdone
  s_sleep 8
  s_branch L_qpoll
L_qdone:
  v_mov_b32 v17, v18
  v_mov_b32 v21, v22
  v_mov_b32 v25, v26
  v_mov_b32 v29, v30
  ds_write_b64 v1, v[16:17]
  ds_write_b64 v1, v[20:21] offset:512
  s_waitcnt lgkmcnt(0)
  ds_write_b32 v2, v8 offset:132
  s_mov_b32 s21, 30
  s_mov_b32 s22, 30
  s_mov_b32 s20, 61
  s_mov_b32 s19, 61
  s_mov_b32 s23, 0
  s_mov_b32 s24, 0
  s_mov_b32 s26, 0
  s_mov_b32 s27, 0
  s_mov_b32 s28, 0
  s_mov_b32 s29, 1
  v_mov_b32 v4, 0
  v_lshl_add_u32 v5, v0, 16, v0
  s_mov_b32 s76, 4194304
  s_movk_i32 s30, 1000
  s_movk_i32 s62, 10
  s_movk_i32 s63, 44
  s_mov_b32 s64, 5046272
  s_mov_b32 s65, 0
L_rel:
  s_mov_b64 exec, 1
  ds_read_b32 v6, v2 offset:128
  s_memrealtime s[60:61]
  s_sub_u32 s30, s30, 1
  s_waitcnt lgkmcnt(0)
  s_sub_u32 s25, s60, s74
  s_sub_i32 s25, s25, s62
  s_max_i32 s25, s25, 0
  s_min_i32 s25, s25, 0x8000
  s_mul_i32 s25, s25, 2259
  s_lshr_b32 s25, s25, 16
  s_cmp_eq_u32 s65, 0
  s_cbranch_scc1 L_fb1
  v_readfirstlane_b32 s31, v10
  s_sub_u32 s31, s31, s74
  s_cmp_eq_u32 s31, -1
  s_cbranch_scc1 L_fb1
  s_mov_b32 s65, 0
  s_cmp_gt_u32 s31, 0xfff
  s_cbranch_scc1 L_fb1
  s_sub_i32 s31, s31, 84
  s_ashr_i32 s31, s31, 3
  s_min_i32 s31, s31, 40
  s_add_i32 s62, s62, s31
L_fb1:
  s_cmp_lt_u32 s25, s63
  s_cbranch_scc1 L_fb2
  s_add_u32 s63, s63, 8
  v_readfirstlane_b32 s31, v6
  s_lshl_b32 s66, s25, 1
  s_sub_i32 s31, s66, s31
  s_sub_i32 s31, s31, 62
  s_max_i32 s31, s31, 0
  s_min_i32 s31, s31, 40
  s_sub_u32 s66, s74, 1
  v_mov_b32 v10, s66
  v_mov_b32 v8, s31
  buffer_load_dword v10, v13, s[12:15], s64 offen
  s_cmp_lg_u32 s64, 5046272
  s_cselect_b32 s65, 1, 0
  s_add_u32 s64, s64, 4352
  s_cmp_ge_u32 s18, 4
  s_cbranch_scc1 L_fb2
  buffer_atomic_add v8, v13, s[12:15], s64 offen sc1
L_fb2:
  s_cmp_eq_u32 s30, 0
  s_cselect_b32 s25, 255, s25
  s_cmp_ge_u32 s25, 121
  s_cselect_b32 s25, 255, s25
  s_sub_i32 s31, s25, 31
  s_min_i32 s31, s31, 30
  s_max_i32 s31, s31, 1
  s_bfm_b64 exec, s31, 0
  ds_write_b32 v64, v65
  s_sub_i32 s31, s25, 61
  s_cmp_le_i32 s31, 0
  s_cbranch_scc1 L_rel2
  s_min_i32 s31, s31, 61
  s_bfm_b64 exec, s31, 0
  ds_write_b32 v66, v67
  s_cmp_eq_u32 s25, 255
  s_cbranch_scc1 L_reld
L_rel2:
  s_sleep 2
  s_branch L_rel
L_reld:
  s_add_u32 s21, s20, 31
  s_mov_b32 s22, s21
  s_cmp_ge_u32 s28, 512
  s_cselect_b32 s29, 1, 0
L_disp1:
  s_mov_b64 exec, 1
  ds_read_b32 v6, v2 offset:128
  s_sub_u32 s76, s76, 1
  s_cmp_le_i32 s76, 0
  s_cbranch_scc1 L_dexh1
  s_cmp_eq_u32 s24, 0
  s_cbranch_scc1 L_noc1
  v_readlane_b32 s25, v4, s27
  s_cmp_lt_u32 s25, 8
  s_cbranch_scc1 L_noc1
  s_and_b32 s30, s23, 15
  s_lshr_b32 s23, s23, 4
  s_sub_u32 s24, s24, 1
  s_add_u32 s27, s27, 1
  s_and_b32 s27, s27, 7
  s_add_u32 s25, s25, 236
  s_add_u32 s28, s25, s30
  s_sub_i32 s31, 256, s25
  s_max_i32 s31, s31, 0
  s_min_i32 s31, s31, s30
  s_cmp_ge_u32 s28, 256
  s_cselect_b32 s29, 1, s29
  s_cmp_eq_u32 s31, 0
  s_cbranch_scc1 L_noc1
  s_bfm_b64 exec, s31, 0
  s_lshl_b32 s30, s20, 16
  s_add_u32 s25, s25, s30
  v_add_u32 v7, s25, v5
  s_lshl_b32 s25, s22, 2
  s_add_u32 s25, s25, 152576
  v_lshl_add_u32 v8, v0, 2, s25
  ds_write_b32 v8, v7
  s_add_u32 s22, s22, s31
  s_lshl_b32 s25, s22, 2
  s_add_u32 s25, s25, 152576
  v_or_b32 v9, 32768, v7
  v_lshl_add_u32 v14, v0, 2, s25
  ds_write_b32 v14, v9
  s_add_u32 s20, s20, s31
  s_add_u32 s22, s22, s31
L_noc1:
  s_cmp_lg_u32 s29, 0
  s_cbranch_scc1 L_exh1
  s_cmp_ge_u32 s24, 4
  s_cbranch_scc1 L_dslp1
  s_waitcnt lgkmcnt(0)
  v_readfirstlane_b32 s25, v6
  s_lshl_b32 s30, s21, 1
  s_add_u32 s25, s25, 14
  s_cmp_ge_u32 s30, s25
  s_cbranch_scc1 L_dslp1
  s_cmp_ge_u32 s28, 240
  s_cselect_b32 s30, 1, 2
  s_add_u32 s25, s19, s30
  s_cmp_gt_u32 s25, 96
  s_cselect_b32 s29, 1, 0
  s_cbranch_scc1 L_exh1
  s_mov_b32 s19, s25
  s_lshl_b64 exec, 1, s26
  v_mov_b32 v4, s30
  buffer_atomic_add v4, v13, s[12:15], s77 offen sc0 sc1
  s_lshl_b32 s25, s24, 2
  s_lshl_b32 s25, s30, s25
  s_or_b32 s23, s23, s25
  s_add_u32 s24, s24, 1
  s_add_u32 s21, s21, s30
  s_add_u32 s21, s21, s30
  s_add_u32 s26, s26, 1
  s_and_b32 s26, s26, 7
  s_branch L_disp1
L_exh1:
  s_cmp_eq_u32 s24, 0
  s_cbranch_scc1 L_dexh1
L_dslp1:
  s_sleep 2
  s_branch L_disp1
L_dexh1:
  s_mov_b64 exec, 0xff
  s_lshl_b32 s25, s22, 2
  s_add_u32 s25, s25, 152576
  v_lshl_add_u32 v8, v0, 2, s25
  v_mov_b32 v7, 512
  ds_write_b32 v8, v7
  s_waitcnt lgkmcnt(0)
  s_endpgm
L_hb:
  s_setprio 3
  v_lshrrev_b32 v6, 3, v0
  v_and_b32 v7, 7, v0
  v_lshlrev_b32 v7, 4, v7
  v_lshl_add_u32 v6, v6, 10, v7
  v_lshlrev_b32 v3, 4, v0
  v_lshrrev_b32 v8, 2, v10
  v_lshl_add_u32 v8, v11, 3, v8
  v_lshlrev_b32 v9, 5, v8
  v_and_b32 v8, 3, v0
  v_lshl_add_u32 v9, v8, 3, v9
  v_add_u32 v9, 131072, v9
  v_cmp_gt_u32 s[58:59], 8, v10
  v_bfe_u32 v61, v0, 2, 3
  v_and_b32 v62, 3, v0
  v_lshl_add_u32 v60, v62, 4, v61
  v_lshlrev_b32 v60, 2, v60
  v_mov_b32 v92, 0
  v_mov_b32 v93, 0
  v_mov_b32 v94, 0
  v_mov_b32 v95, 0
  v_add_u32 v1, 155648, v3
  v_mov_b32 v15, 149504
  v_mov_b32 v16, -1
  v_mov_b32 v17, -1
  v_lshl_add_u32 v98, v0, 3, v15
  ds_write_b64 v98, v[16:17] offset:256
  s_waitcnt lgkmcnt(0)
  s_mov_b32 s64, s32
  s_mov_b32 s65, s33
  s_mov_b32 s66, 0x2000
  s_mov_b32 s67, 0x00020000
  s_mov_b32 s12, s56
  s_mov_b32 s13, s57
  s_mov_b32 s14, 0x500000
  s_mov_b32 s15, 0x00020000
  s_mov_b32 s4, s48
  s_mov_b32 s5, s49
  s_mov_b32 s6, 0x1c0000
  s_mov_b32 s7, 0x00020000
  s_mov_b32 s8, s50
  s_mov_b32 s9, s51
  s_mov_b32 s10, 0x400
  s_mov_b32 s11, 0x00020000
  s_mov_b32 s60, s40
  s_mov_b32 s61, s41
  s_mov_b32 s62, 0x400000
  s_mov_b32 s63, 0x00020000
  s_lshl_b32 s27, s17, 7
  s_mul_i32 s26, s18, 57344
  s_add_u32 s26, s26, s27
  s_and_b32 s25, s18, 1
  s_lshl_b32 s25, s25, 12
  v_lshrrev_b32 v12, 2, v0
  v_lshlrev_b32 v12, 6, v12
  v_and_b32 v7, 3, v0
  v_lshl_add_u32 v7, v7, 10, v12
  s_barrier
  s_mov_b32 s72, s26
  s_mov_b32 s76, 1048576
  buffer_load_dwordx4 v[32:35], v12, s[8:11], 0 offen offset:0
  buffer_load_dwordx4 v[36:39], v12, s[8:11], 0 offen offset:16
  buffer_load_dwordx4 v[40:43], v12, s[8:11], 0 offen offset:32
  buffer_load_dwordx4 v[44:47], v12, s[8:11], 0 offen offset:48
L_r1w:
  ds_read_b32 v8, v15 offset:136
  s_waitcnt lgkmcnt(0)
  v_cmp_eq_u32 vcc, 0, v8
  s_sub_u32 s76, s76, 1
  s_cmp_eq_u32 s76, 0
  s_cbranch_scc1 L_r1done
  s_cmp_eq_u64 vcc, 0
  s_cbranch_scc1 L_r1done
  s_sleep 2
  s_branch L_r1w
L_r1done:
  ds_read_b32 v166, v15 offset:96
  v_add_u32 v7, s25, v7
  v_lshrrev_b32 v8, 6, v7
  v_and_b32 v8, 0x70, v8
  v_xor_b32 v7, v7, v8
  v_xor_b32 v8, 0, v7
  v_add_u32 v8, 155648, v8
  ds_read_b128 v[16:19], v8
  v_xor_b32 v8, 16, v7
  v_add_u32 v8, 155648, v8
  ds_read_b128 v[20:23], v8
  v_xor_b32 v8, 32, v7
  v_add_u32 v8, 155648, v8
  ds_read_b128 v[24:27], v8
  v_xor_b32 v8, 48, v7
  v_add_u32 v8, 155648, v8
  ds_read_b128 v[28:31], v8
  s_waitcnt vmcnt(0) lgkmcnt(0)
  v_readfirstlane_b32 s74, v166
  v_mov_b32 v57, v166
  v_mov_b32 v59, v166
  ds_write_b128 v1, v[92:95] offset:7168
  v_lshlrev_b32 v48, 16, v16
  v_and_b32 v49, 0xffff0000, v16
  v_lshlrev_b32 v50, 16, v32
  v_and_b32 v51, 0xffff0000, v32
  v_mul_f32 v48, v48, v50
  v_mul_f32 v49, v49, v51
  v_cvt_pk_bf16_f32 v48, v48, v49
  v_and_b32 v49, 0xffff0000, v48
  v_lshlrev_b32 v48, 16, v48
  v_add_f32 v52, v48, v49
  v_lshlrev_b32 v48, 16, v17
  v_and_b32 v49, 0xffff0000, v17
  v_lshlrev_b32 v50, 16, v33
  v_and_b32 v51, 0xffff0000, v33
  v_mul_f32 v48, v48, v50
  v_mul_f32 v49, v49, v51
  v_cvt_pk_bf16_f32 v48, v48, v49
  v_and_b32 v49, 0xffff0000, v48
  v_lshlrev_b32 v48, 16, v48
  v_add_f32 v48, v48, v49
  v_add_f32 v52, v52, v48
  v_lshlrev_b32 v48, 16, v18
  v_and_b32 v49, 0xffff0000, v18
  v_lshlrev_b32 v50, 16, v34
  v_and_b32 v51, 0xffff0000, v34
  v_mul_f32 v48, v48, v50
  v_mul_f32 v49, v49, v51
  v_cvt_pk_bf16_f32 v48, v48, v49
  v_and_b32 v49, 0xffff0000, v48
  v_lshlrev_b32 v48, 16, v48
  v_add_f32 v48, v48, v49
  v_add_f32 v52, v52, v48
  v_lshlrev_b32 v48, 16, v19
  v_and_b32 v49, 0xffff0000, v19
  v_lshlrev_b32 v50, 16, v35
  v_and_b32 v51, 0xffff0000, v35
  v_mul_f32 v48, v48, v50
  v_mul_f32 v49, v49, v51
  v_cvt_pk_bf16_f32 v48, v48, v49
  v_and_b32 v49, 0xffff0000, v48
  v_lshlrev_b32 v48, 16, v48
  v_add_f32 v48, v48, v49
  v_add_f32 v52, v52, v48
  v_lshlrev_b32 v48, 16, v20
  v_and_b32 v49, 0xffff0000, v20
  v_lshlrev_b32 v50, 16, v36
  v_and_b32 v51, 0xffff0000, v36
  v_mul_f32 v48, v48, v50
  v_mul_f32 v49, v49, v51
  v_cvt_pk_bf16_f32 v48, v48, v49
  v_and_b32 v49, 0xffff0000, v48
  v_lshlrev_b32 v48, 16, v48
  v_add_f32 v48, v48, v49
  v_add_f32 v52, v52, v48
  v_lshlrev_b32 v48, 16, v21
  v_and_b32 v49, 0xffff0000, v21
  v_lshlrev_b32 v50, 16, v37
  v_and_b32 v51, 0xffff0000, v37
  v_mul_f32 v48, v48, v50
  v_mul_f32 v49, v49, v51
  v_cvt_pk_bf16_f32 v48, v48, v49
  v_and_b32 v49, 0xffff0000, v48
  v_lshlrev_b32 v48, 16, v48
  v_add_f32 v48, v48, v49
  v_add_f32 v52, v52, v48
  v_lshlrev_b32 v48, 16, v22
  v_and_b32 v49, 0xffff0000, v22
  v_lshlrev_b32 v50, 16, v38
  v_and_b32 v51, 0xffff0000, v38
  v_mul_f32 v48, v48, v50
  v_mul_f32 v49, v49, v51
  v_cvt_pk_bf16_f32 v48, v48, v49
  v_and_b32 v49, 0xffff0000, v48
  v_lshlrev_b32 v48, 16, v48
  v_add_f32 v48, v48, v49
  v_add_f32 v52, v52, v48
  v_lshlrev_b32 v48, 16, v23
  v_and_b32 v49, 0xffff0000, v23
  v_lshlrev_b32 v50, 16, v39
  v_and_b32 v51, 0xffff0000, v39
  v_mul_f32 v48, v48, v50
  v_mul_f32 v49, v49, v51
  v_cvt_pk_bf16_f32 v48, v48, v49
  v_and_b32 v49, 0xffff0000, v48
  v_lshlrev_b32 v48, 16, v48
  v_add_f32 v48, v48, v49
  v_add_f32 v52, v52, v48
  v_lshlrev_b32 v48, 16, v24
  v_and_b32 v49, 0xffff0000, v24
  v_lshlrev_b32 v50, 16, v40
  v_and_b32 v51, 0xffff0000, v40
  v_mul_f32 v48, v48, v50
  v_mul_f32 v49, v49, v51
  v_cvt_pk_bf16_f32 v48, v48, v49
  v_and_b32 v49, 0xffff0000, v48
  v_lshlrev_b32 v48, 16, v48
  v_add_f32 v48, v48, v49
  v_add_f32 v52, v52, v48
  v_lshlrev_b32 v48, 16, v25
  v_and_b32 v49, 0xffff0000, v25
  v_lshlrev_b32 v50, 16, v41
  v_and_b32 v51, 0xffff0000, v41
  v_mul_f32 v48, v48, v50
  v_mul_f32 v49, v49, v51
  v_cvt_pk_bf16_f32 v48, v48, v49
  v_and_b32 v49, 0xffff0000, v48
  v_lshlrev_b32 v48, 16, v48
  v_add_f32 v48, v48, v49
  v_add_f32 v52, v52, v48
  v_lshlrev_b32 v48, 16, v26
  v_and_b32 v49, 0xffff0000, v26
  v_lshlrev_b32 v50, 16, v42
  v_and_b32 v51, 0xffff0000, v42
  v_mul_f32 v48, v48, v50
  v_mul_f32 v49, v49, v51
  v_cvt_pk_bf16_f32 v48, v48, v49
  v_and_b32 v49, 0xffff0000, v48
  v_lshlrev_b32 v48, 16, v48
  v_add_f32 v48, v48, v49
  v_add_f32 v52, v52, v48
  v_lshlrev_b32 v48, 16, v27
  v_and_b32 v49, 0xffff0000, v27
  v_lshlrev_b32 v50, 16, v43
  v_and_b32 v51, 0xffff0000, v43
  v_mul_f32 v48, v48, v50
  v_mul_f32 v49, v49, v51
  v_cvt_pk_bf16_f32 v48, v48, v49
  v_and_b32 v49, 0xffff0000, v48
  v_lshlrev_b32 v48, 16, v48
  v_add_f32 v48, v48, v49
  v_add_f32 v52, v52, v48
  v_lshlrev_b32 v48, 16, v28
  v_and_b32 v49, 0xffff0000, v28
  v_lshlrev_b32 v50, 16, v44
  v_and_b32 v51, 0xffff0000, v44
  v_mul_f32 v48, v48, v50
  v_mul_f32 v49, v49, v51
  v_cvt_pk_bf16_f32 v48, v48, v49
  v_and_b32 v49, 0xffff0000, v48
  v_lshlrev_b32 v48, 16, v48
  v_add_f32 v48, v48, v49
  v_add_f32 v52, v52, v48
  v_lshlrev_b32 v48, 16, v29
  v_and_b32 v49, 0xffff0000, v29
  v_lshlrev_b32 v50, 16, v45
  v_and_b32 v51, 0xffff0000, v45
  v_mul_f32 v48, v48, v50
  v_mul_f32 v49, v49, v51
  v_cvt_pk_bf16_f32 v48, v48, v49
  v_and_b32 v49, 0xffff0000, v48
  v_lshlrev_b32 v48, 16, v48
  v_add_f32 v48, v48, v49
  v_add_f32 v52, v52, v48
  v_lshlrev_b32 v48, 16, v30
  v_and_b32 v49, 0xffff0000, v30
  v_lshlrev_b32 v50, 16, v46
  v_and_b32 v51, 0xffff0000, v46
  v_mul_f32 v48, v48, v50
  v_mul_f32 v49, v49, v51
  v_cvt_pk_bf16_f32 v48, v48, v49
  v_and_b32 v49, 0xffff0000, v48
  v_lshlrev_b32 v48, 16, v48
  v_add_f32 v48, v48, v49
  v_add_f32 v52, v52, v48
  v_lshlrev_b32 v48, 16, v31
  v_and_b32 v49, 0xffff0000, v31
  v_lshlrev_b32 v50, 16, v47
  v_and_b32 v51, 0xffff0000, v47
  v_mul_f32 v48, v48, v50
  v_mul_f32 v49, v49, v51
  v_cvt_pk_bf16_f32 v48, v48, v49
  v_and_b32 v49, 0xffff0000, v48
  v_lshlrev_b32 v48, 16, v48
  v_add_f32 v48, v48, v49
  v_add_f32 v52, v52, v48
  v_mov_b32 v24, v52
  s_nop 1
  v_add_f32_dpp v24, v24, v24 row_ror:8 row_mask:0xf bank_mask:0xf
  s_nop 1
  v_add_f32_dpp v24, v24, v24 row_ror:4 row_mask:0xf bank_mask:0xf
  v_mov_b32 v25, v24
  s_nop 1
  v_permlane16_swap_b32 v24, v25
  v_add_f32 v24, v24, v25
  v_mov_b32 v25, v24
  s_nop 1
  v_permlane32_swap_b32 v24, v25
  v_add_f32 v24, v24, v25
  v_cvt_pk_bf16_f32 v24, v24, v24
  v_lshlrev_b32 v24, 16, v24
  v_mul_f32 v24, 0xbfb8aa3b, v24
  v_exp_f32 v24, v24
  s_nop 0
  v_add_f32 v24, 1.0, v24
  v_rcp_f32 v24, v24
  s_nop 0
  v_cvt_pk_bf16_f32 v24, v24, v24
  v_lshlrev_b32 v164, 16, v24
  v_sub_f32 v25, 1.0, v164
  v_cvt_pk_bf16_f32 v25, v25, v25
  v_lshlrev_b32 v165, 16, v25
  s_lshl_b32 s26, s18, 17
  s_lshl_b32 s27, s17, 7
  s_add_u32 s26, s26, s27
  s_waitcnt vmcnt(0)
  s_mov_b32 s30, s25
L_nohpub:
  s_getreg_b32 s31, hwreg(HW_REG_XCC_ID, 0, 4)
  s_xor_b32 s31, s31, s74
  s_lshl_b32 s29, s17, 8
  s_add_u32 s29, s29, 393216
  s_lshl_b32 s27, s18, 3
  s_add_u32 s27, s27, s29
  v_mov_b32 v167, s31
  v_lshlrev_b32 v66, 3, v0
  v_and_b32 v66, 0xff, v66
  s_mov_b64 exec, 1
  buffer_store_dwordx2 v[166:167], v66, s[12:15], s27 offen sc1
  s_mov_b64 exec, -1
  s_mov_b32 s73, s26
  s_mov_b32 s42, 0x7060500
  s_mov_b32 s43, 0x7060501
  s_mov_b32 s44, 0x7060502
  s_mov_b32 s45, 0x7060503
  s_mov_b32 s46, 0x0c0c0400
  s_mov_b32 s47, 0x04000c0c
  s_mov_b32 s30, 131072
  s_mov_b32 s27, 196608
  s_mul_i32 s25, s18, 7
  v_add_u32 v1, s25, v11
  v_lshrrev_b32 v2, 2, v1
  v_and_b32 v1, 3, v1
  v_lshlrev_b32 v1, 5, v1
  v_lshl_add_u32 v1, v2, 10, v1
  v_lshl_add_u32 v1, v10, 7, v1
  v_mov_b32 v4, 0x7ff00000
  v_cmp_gt_u32 vcc, 3, v11
  s_and_b64 s[66:67], s[58:59], vcc
  v_cndmask_b32 v2, v4, v1, s[66:67]
  v_cndmask_b32 v1, v4, v1, s[58:59]
  v_lshlrev_b32 v14, 4, v10
  v_lshl_add_u32 v14, v11, 7, v14
  v_add_u32 v14, 155648, v14
  s_mov_b32 s76, 65536
  s_sleep 127
  s_sleep 127
L_hpoll:
  buffer_load_dwordx4 v[16:19], v1, s[12:15], s30 offen sc1
  buffer_load_dwordx4 v[20:23], v1, s[12:15], s30 offen offset:16 sc1
  buffer_load_dwordx4 v[24:27], v2, s[12:15], s30 offen offset:1024 sc1
  buffer_load_dwordx4 v[28:31], v2, s[12:15], s30 offen offset:1040 sc1
  buffer_load_dwordx4 v[32:35], v1, s[12:15], s27 offen sc1
  buffer_load_dwordx4 v[36:39], v1, s[12:15], s27 offen offset:16 sc1
  buffer_load_dwordx4 v[40:43], v2, s[12:15], s27 offen offset:1024 sc1
  buffer_load_dwordx4 v[44:47], v2, s[12:15], s27 offen offset:1040 sc1
  buffer_load_dwordx2 v[64:65], v66, s[12:15], s29 offen sc1
  s_waitcnt vmcnt(0)
  v_cmp_ne_u32 vcc, s74, v17
  v_cmp_ne_u32 s[78:79], s74, v19
  s_or_b64 vcc, vcc, s[78:79]
  v_cmp_ne_u32 s[78:79], s74, v21
  s_or_b64 vcc, vcc, s[78:79]
  v_cmp_ne_u32 s[78:79], s74, v23
  s_or_b64 vcc, vcc, s[78:79]
  v_cmp_ne_u32 s[78:79], s74, v33
  s_or_b64 vcc, vcc, s[78:79]
  v_cmp_ne_u32 s[78:79], s74, v35
  s_or_b64 vcc, vcc, s[78:79]
  v_cmp_ne_u32 s[78:79], s74, v37
  s_or_b64 vcc, vcc, s[78:79]
  v_cmp_ne_u32 s[78:79], s74, v39
  s_or_b64 vcc, vcc, s[78:79]
  s_and_b64 s[64:65], vcc, s[58:59]
  v_cmp_ne_u32 vcc, s74, v64
  s_or_b64 s[64:65], s[64:65], vcc
  v_xor_b32 v67, s74, v65
  v_cmp_lt_u32 vcc, 15, v67
  s_or_b64 s[64:65], s[64:65], vcc
  v_cmp_ne_u32 vcc, s74, v25
  v_cmp_ne_u32 s[78:79], s74, v27
  s_or_b64 vcc, vcc, s[78:79]
  v_cmp_ne_u32 s[78:79], s74, v29
  s_or_b64 vcc, vcc, s[78:79]
  v_cmp_ne_u32 s[78:79], s74, v31
  s_or_b64 vcc, vcc, s[78:79]
  v_cmp_ne_u32 s[78:79], s74, v41
  s_or_b64 vcc, vcc, s[78:79]
  v_cmp_ne_u32 s[78:79], s74, v43
  s_or_b64 vcc, vcc, s[78:79]
  v_cmp_ne_u32 s[78:79], s74, v45
  s_or_b64 vcc, vcc, s[78:79]
  v_cmp_ne_u32 s[78:79], s74, v47
  s_or_b64 vcc, vcc, s[78:79]
  s_and_b64 vcc, vcc, s[66:67]
  s_or_b64 vcc, vcc, s[64:65]
  s_sub_u32 s76, s76, 1
  s_cmp_eq_u32 s76, 0
  s_cbranch_scc1 L_hdone
  s_cmp_eq_u64 vcc, 0
  s_cbranch_scc1 L_hdone
  s_sleep 32
  s_branch L_hpoll
L_hdone:
  v_cmp_ne_u32 vcc, s31, v65
  s_cmp_eq_u64 vcc, 0
  s_cselect_b32 s28, 1, 0
  s_mov_b32 s25, 0x3d372713
  s_mov_b32 s26, 0xc0135761
  v_lshrrev_b32 v1, 2, v10
  v_lshl_add_u32 v1, v11, 3, v1
  v_lshlrev_b32 v1, 7, v1
  v_and_b32 v2, 3, v0
  v_lshl_add_u32 v1, v2, 3, v1
  v_add_u32 v1, 155648, v1
  v_lshlrev_b32 v56, 16, v16
  v_and_b32 v57, 0xffff0000, v16
  v_lshlrev_b32 v58, 16, v32
  v_and_b32 v59, 0xffff0000, v32
  v_mul_f32 v60, v56, v56
  v_mul_f32 v61, v57, v57
  v_mul_f32 v60, v60, v56
  v_mul_f32 v61, v61, v57
  v_fma_f32 v60, v60, s25, v56
  v_fma_f32 v61, v61, s25, v57
  v_mul_f32 v60, s26, v60
  v_mul_f32 v61, s26, v61
  v_exp_f32 v60, v60
  v_exp_f32 v61, v61
  v_add_f32 v60, 1.0, v60
  v_add_f32 v61, 1.0, v61
  v_rcp_f32 v60, v60
  v_rcp_f32 v61, v61
  v_mul_f32 v60, v60, v56
  v_mul_f32 v61, v61, v57
  v_cvt_pk_bf16_f32 v60, v60, v61
  v_and_b32 v61, 0xffff0000, v60
  v_lshlrev_b32 v60, 16, v60
  v_mul_f32 v60, v60, v58
  v_mul_f32 v61, v61, v59
  v_cvt_pk_bf16_f32 v48, v60, v61
  v_lshlrev_b32 v56, 16, v18
  v_and_b32 v57, 0xffff0000, v18
  v_lshlrev_b32 v58, 16, v34
  v_and_b32 v59, 0xffff0000, v34
  v_mul_f32 v60, v56, v56
  v_mul_f32 v61, v57, v57
  v_mul_f32 v60, v60, v56
  v_mul_f32 v61, v61, v57
  v_fma_f32 v60, v60, s25, v56
  v_fma_f32 v61, v61, s25, v57
  v_mul_f32 v60, s26, v60
  v_mul_f32 v61, s26, v61
  v_exp_f32 v60, v60
  v_exp_f32 v61, v61
  v_add_f32 v60, 1.0, v60
  v_add_f32 v61, 1.0, v61
  v_rcp_f32 v60, v60
  v_rcp_f32 v61, v61
  v_mul_f32 v60, v60, v56
  v_mul_f32 v61, v61, v57
  v_cvt_pk_bf16_f32 v60, v60, v61
  v_and_b32 v61, 0xffff0000, v60
  v_lshlrev_b32 v60, 16, v60
  v_mul_f32 v60, v60, v58
  v_mul_f32 v61, v61, v59
  v_cvt_pk_bf16_f32 v49, v60, v61
  v_lshlrev_b32 v56, 16, v20
  v_and_b32 v57, 0xffff0000, v20
  v_lshlrev_b32 v58, 16, v36
  v_and_b32 v59, 0xffff0000, v36
  v_mul_f32 v60, v56, v56
  v_mul_f32 v61, v57, v57
  v_mul_f32 v60, v60, v56
  v_mul_f32 v61, v61, v57
  v_fma_f32 v60, v60, s25, v56
  v_fma_f32 v61, v61, s25, v57
  v_mul_f32 v60, s26, v60
  v_mul_f32 v61, s26, v61
  v_exp_f32 v60, v60
  v_exp_f32 v61, v61
  v_add_f32 v60, 1.0, v60
  v_add_f32 v61, 1.0, v61
  v_rcp_f32 v60, v60
  v_rcp_f32 v61, v61
  v_mul_f32 v60, v60, v56
  v_mul_f32 v61, v61, v57
  v_cvt_pk_bf16_f32 v60, v60, v61
  v_and_b32 v61, 0xffff0000, v60
  v_lshlrev_b32 v60, 16, v60
  v_mul_f32 v60, v60, v58
  v_mul_f32 v61, v61, v59
  v_cvt_pk_bf16_f32 v50, v60, v61
  v_lshlrev_b32 v56, 16, v22
  v_and_b32 v57, 0xffff0000, v22
  v_lshlrev_b32 v58, 16, v38
  v_and_b32 v59, 0xffff0000, v38
  v_mul_f32 v60, v56, v56
  v_mul_f32 v61, v57, v57
  v_mul_f32 v60, v60, v56
  v_mul_f32 v61, v61, v57
  v_fma_f32 v60, v60, s25, v56
  v_fma_f32 v61, v61, s25, v57
  v_mul_f32 v60, s26, v60
  v_mul_f32 v61, s26, v61
  v_exp_f32 v60, v60
  v_exp_f32 v61, v61
  v_add_f32 v60, 1.0, v60
  v_add_f32 v61, 1.0, v61
  v_rcp_f32 v60, v60
  v_rcp_f32 v61, v61
  v_mul_f32 v60, v60, v56
  v_mul_f32 v61, v61, v57
  v_cvt_pk_bf16_f32 v60, v60, v61
  v_and_b32 v61, 0xffff0000, v60
  v_lshlrev_b32 v60, 16, v60
  v_mul_f32 v60, v60, v58
  v_mul_f32 v61, v61, v59
  v_cvt_pk_bf16_f32 v51, v60, v61
  v_lshlrev_b32 v56, 16, v24
  v_and_b32 v57, 0xffff0000, v24
  v_lshlrev_b32 v58, 16, v40
  v_and_b32 v59, 0xffff0000, v40
  v_mul_f32 v60, v56, v56
  v_mul_f32 v61, v57, v57
  v_mul_f32 v60, v60, v56
  v_mul_f32 v61, v61, v57
  v_fma_f32 v60, v60, s25, v56
  v_fma_f32 v61, v61, s25, v57
  v_mul_f32 v60, s26, v60
  v_mul_f32 v61, s26, v61
  v_exp_f32 v60, v60
  v_exp_f32 v61, v61
  v_add_f32 v60, 1.0, v60
  v_add_f32 v61, 1.0, v61
  v_rcp_f32 v60, v60
  v_rcp_f32 v61, v61
  v_mul_f32 v60, v60, v56
  v_mul_f32 v61, v61, v57
  v_cvt_pk_bf16_f32 v60, v60, v61
  v_and_b32 v61, 0xffff0000, v60
  v_lshlrev_b32 v60, 16, v60
  v_mul_f32 v60, v60, v58
  v_mul_f32 v61, v61, v59
  v_cvt_pk_bf16_f32 v52, v60, v61
  v_lshlrev_b32 v56, 16, v26
  v_and_b32 v57, 0xffff0000, v26
  v_lshlrev_b32 v58, 16, v42
  v_and_b32 v59, 0xffff0000, v42
  v_mul_f32 v60, v56, v56
  v_mul_f32 v61, v57, v57
  v_mul_f32 v60, v60, v56
  v_mul_f32 v61, v61, v57
  v_fma_f32 v60, v60, s25, v56
  v_fma_f32 v61, v61, s25, v57
  v_mul_f32 v60, s26, v60
  v_mul_f32 v61, s26, v61
  v_exp_f32 v60, v60
  v_exp_f32 v61, v61
  v_add_f32 v60, 1.0, v60
  v_add_f32 v61, 1.0, v61
  v_rcp_f32 v60, v60
  v_rcp_f32 v61, v61
  v_mul_f32 v60, v60, v56
  v_mul_f32 v61, v61, v57
  v_cvt_pk_bf16_f32 v60, v60, v61
  v_and_b32 v61, 0xffff0000, v60
  v_lshlrev_b32 v60, 16, v60
  v_mul_f32 v60, v60, v58
  v_mul_f32 v61, v61, v59
  v_cvt_pk_bf16_f32 v53, v60, v61
  v_lshlrev_b32 v56, 16, v28
  v_and_b32 v57, 0xffff0000, v28
  v_lshlrev_b32 v58, 16, v44
  v_and_b32 v59, 0xffff0000, v44
  v_mul_f32 v60, v56, v56
  v_mul_f32 v61, v57, v57
  v_mul_f32 v60, v60, v56
  v_mul_f32 v61, v61, v57
  v_fma_f32 v60, v60, s25, v56
  v_fma_f32 v61, v61, s25, v57
  v_mul_f32 v60, s26, v60
  v_mul_f32 v61, s26, v61
  v_exp_f32 v60, v60
  v_exp_f32 v61, v61
  v_add_f32 v60, 1.0, v60
  v_add_f32 v61, 1.0, v61
  v_rcp_f32 v60, v60
  v_rcp_f32 v61, v61
  v_mul_f32 v60, v60, v56
  v_mul_f32 v61, v61, v57
  v_cvt_pk_bf16_f32 v60, v60, v61
  v_and_b32 v61, 0xffff0000, v60
  v_lshlrev_b32 v60, 16, v60
  v_mul_f32 v60, v60, v58
  v_mul_f32 v61, v61, v59
  v_cvt_pk_bf16_f32 v54, v60, v61
  v_lshlrev_b32 v56, 16, v30
  v_and_b32 v57, 0xffff0000, v30
  v_lshlrev_b32 v58, 16, v46
  v_and_b32 v59, 0xffff0000, v46
  v_mul_f32 v60, v56, v56
  v_mul_f32 v61, v57, v57
  v_mul_f32 v60, v60, v56
  v_mul_f32 v61, v61, v57
  v_fma_f32 v60, v60, s25, v56
  v_fma_f32 v61, v61, s25, v57
  v_mul_f32 v60, s26, v60
  v_mul_f32 v61, s26, v61
  v_exp_f32 v60, v60
  v_exp_f32 v61, v61
  v_add_f32 v60, 1.0, v60
  v_add_f32 v61, 1.0, v61
  v_rcp_f32 v60, v60
  v_rcp_f32 v61, v61
  v_mul_f32 v60, v60, v56
  v_mul_f32 v61, v61, v57
  v_cvt_pk_bf16_f32 v60, v60, v61
  v_and_b32 v61, 0xffff0000, v60
  v_lshlrev_b32 v60, 16, v60
  v_mul_f32 v60, v60, v58
  v_mul_f32 v61, v61, v59
  v_cvt_pk_bf16_f32 v55, v60, v61
  v_and_b32 v14, 3, v0
  v_lshlrev_b32 v14, 4, v14
  v_lshrrev_b32 v2, 2, v10
  v_lshl_add_u32 v14, v2, 12, v14
  v_lshl_add_u32 v14, v11, 13, v14
  s_lshl_b32 s75, s17, 17
  s_lshl_b32 s26, s18, 7
  s_add_u32 s75, s75, s26
  s_add_u32 s75, s75, 2097216
  v_lshl_add_u32 v2, v62, 3, v15
  s_mov_b64 exec, 15
  ds_write_b64 v2, v[164:165] offset:64
  v_mov_b32 v8, s28
  ds_write_b32 v15, v8 offset:140
  s_mov_b32 s8, s52
  s_mov_b32 s9, s53
  s_mov_b32 s10, 0x2000
  s_mov_b32 s11, 0x00020000
  s_mov_b64 exec, 1
  s_lshl_b32 s25, s17, 7
  s_mov_b32 s26, 0x3f0000
  v_mov_b32 v16, 0
  buffer_load_dword v17, v16, s[8:11], s25 offen
  buffer_load_dword v18, v16, s[12:15], s26 offen
  buffer_load_dword v19, v16, s[60:63], s73 offen nt
  buffer_load_dword v42, v16, s[4:7], s72 offen nt
  s_mov_b64 exec, -1
  v_lshl_add_u32 v20, v0, 3, v15
  v_lshl_add_u32 v21, v0, 2, v15
  v_lshrrev_b32 v22, 5, v0
  v_bfe_u32 v23, v0, 3, 2
  v_lshl_add_u32 v22, v22, 5, v23
  v_mul_u32_u24 v22, 64, v22
  s_lshl_b32 s25, s20, 4
  s_add_u32 s25, s25, s19
  s_lshr_b32 s26, s17, 2
  s_lshl3_add_u32 s25, s26, s25
  s_and_b32 s26, s17, 3
  s_mul_i32 s25, s25, 256
  s_lshl_b32 s26, s26, 3
  s_add_u32 s25, s25, s26
  s_add_u32 s25, s25, 262144
  s_mov_b32 s26, 0x3fb8aa3b
  v_mov_b32 v31, v166
  s_mov_b32 s76, 4194304
L_we:
  ds_read_b64 v[24:25], v20 offset:256
  s_sub_u32 s76, s76, 1
  s_cbranch_scc1 L_wed
  s_waitcnt lgkmcnt(0)
  v_cmp_eq_u32 vcc, -1, v25
  s_bcnt1_i32_b64 s27, vcc
  s_cmp_lt_u32 s27, 17
  s_cbranch_scc1 L_wed
  s_sleep 1
  s_cmp_lt_u32 s27, 32
  s_cbranch_scc1 L_we
  s_sleep 8
  s_branch L_we
L_wed:
  s_mov_b32 m0, 131072
  s_nop 0
  buffer_load_dwordx4 v6, s[60:63], s73 offen nt lds
  s_add_u32 s73, s73, 8192
  s_mov_b32 m0, 132096
  s_nop 0
  buffer_load_dwordx4 v6, s[60:63], s73 offen nt lds
  s_add_u32 s73, s73, 8192
  s_mov_b32 m0, 133120
  s_nop 0
  buffer_load_dwordx4 v6, s[60:63], s73 offen nt lds
  s_add_u32 s73, s73, 8192
  s_mov_b32 m0, 134144
  s_nop 0
  buffer_load_dwordx4 v6, s[60:63], s73 offen nt lds
  s_add_u32 s73, s73, 8192
  s_mov_b32 m0, 135168
  s_nop 0
  buffer_load_dwordx4 v6, s[60:63], s73 offen nt lds
  s_add_u32 s73, s73, 8192
  s_mov_b32 m0, 136192
  s_nop 0
  buffer_load_dwordx4 v6, s[60:63], s73 offen nt lds
  s_add_u32 s73, s73, 8192
  s_mov_b32 m0, 137216
  s_nop 0
  buffer_load_dwordx4 v6, s[60:63], s73 offen nt lds
  s_add_u32 s73, s73, 8192
  s_mov_b32 m0, 138240
  s_nop 0
  buffer_load_dwordx4 v6, s[60:63], s73 offen nt lds
  s_add_u32 s73, s73, 8192
  s_mov_b32 m0, 139264
  s_nop 0
  buffer_load_dwordx4 v6, s[60:63], s73 offen nt lds
  s_add_u32 s73, s73, 8192
  s_mov_b32 m0, 140288
  s_nop 0
  buffer_load_dwordx4 v6, s[60:63], s73 offen nt lds
  s_add_u32 s73, s73, 8192
  s_mov_b32 m0, 141312
  s_nop 0
  buffer_load_dwordx4 v6, s[60:63], s73 offen nt lds
  s_add_u32 s73, s73, 8192
  s_mov_b32 m0, 142336
  s_nop 0
  buffer_load_dwordx4 v6, s[60:63], s73 offen nt lds
  s_add_u32 s73, s73, 8192
  s_mov_b32 m0, 143360
  s_nop 0
  buffer_load_dwordx4 v6, s[60:63], s73 offen nt lds
  s_add_u32 s73, s73, 8192
  s_mov_b32 m0, 144384
  s_nop 0
  buffer_load_dwordx4 v6, s[60:63], s73 offen nt lds
  s_add_u32 s73, s73, 8192
  s_mov_b32 m0, 145408
  s_nop 0
  buffer_load_dwordx4 v6, s[60:63], s73 offen nt lds
  s_add_u32 s73, s73, 8192
  s_mov_b32 m0, 146432
  s_nop 0
  buffer_load_dwordx4 v6, s[60:63], s73 offen nt lds
  s_lshl_b32 s27, s17, 17
  s_lshl_b32 s29, s18, 12
  s_add_u32 s27, s27, s29
  s_add_u32 s27, s27, 2097152
  v_lshlrev_b32 v40, 7, v0
  s_mov_b32 exec_hi, 0
  buffer_load_dword v41, v40, s[12:15], s27 offen
  s_mov_b32 exec_hi, -1
L_bw:
  ds_read_b64 v[24:25], v20 offset:256
  s_sub_u32 s76, s76, 1
  s_cbranch_scc1 L_bwd
  s_waitcnt lgkmcnt(0)
  v_cmp_eq_u32 vcc, -1, v25
  s_cbranch_vccz L_bwd
  s_bcnt1_i32_b64 s27, vcc
  s_sleep 1
  s_cmp_lt_u32 s27, 32
  s_cbranch_scc1 L_bw
  s_sleep 8
  s_branch L_bw
L_bwd:
  s_waitcnt lgkmcnt(0)
  v_max_f32_dpp v26, v24, v24 quad_perm:[1,0,3,2] row_mask:0xf bank_mask:0xf
  s_nop 1
  v_max_f32_dpp v26, v26, v26 quad_perm:[2,3,0,1] row_mask:0xf bank_mask:0xf
  s_nop 1
  v_max_f32_dpp v26, v26, v26 row_half_mirror row_mask:0xf bank_mask:0xf
  v_sub_f32 v24, v24, v26
  v_mul_f32 v24, s26, v24
  v_exp_f32 v24, v24
  s_nop 0
  v_mul_f32 v27, v24, v25
  s_nop 1
  v_add_f32_dpp v27, v27, v27 quad_perm:[1,0,3,2] row_mask:0xf bank_mask:0xf
  s_nop 1
  v_add_f32_dpp v27, v27, v27 quad_perm:[2,3,0,1] row_mask:0xf bank_mask:0xf
  s_nop 1
  v_add_f32_dpp v27, v27, v27 row_half_mirror row_mask:0xf bank_mask:0xf
  v_max_f32 v27, 0x0da24260, v27
  v_rcp_f32 v29, v27
  v_log_f32 v28, v27
  v_mul_f32 v24, v24, v29
  ds_write_b32 v21, v24 offset:768
  v_fma_f32 v30, v26, s26, v28
  v_perm_b32 v30, v30, v166, s42
  s_mov_b32 exec_lo, 0x1010101
  s_mov_b32 exec_hi, 0
  buffer_store_dwordx2 v[30:31], v22, s[12:15], s25 offen sc1
  s_mov_b64 exec, -1
  s_waitcnt lgkmcnt(0)
  s_barrier
  s_mov_b32 m0, 155648
  s_nop 0
  buffer_load_dwordx4 v6, s[4:7], s72 offen nt lds
  s_add_u32 s72, s72, 8192
  s_mov_b32 m0, 156672
  s_nop 0
  buffer_load_dwordx4 v6, s[4:7], s72 offen nt lds
  s_add_u32 s72, s72, 8192
  s_mov_b32 m0, 157696
  s_nop 0
  buffer_load_dwordx4 v6, s[4:7], s72 offen nt lds
  s_add_u32 s72, s72, 8192
  s_mov_b32 m0, 158720
  s_nop 0
  buffer_load_dwordx4 v6, s[4:7], s72 offen nt lds
  s_add_u32 s72, s72, 8192
  s_mov_b32 m0, 159744
  s_nop 0
  buffer_load_dwordx4 v6, s[4:7], s72 offen nt lds
  s_add_u32 s72, s72, 8192
  s_mov_b32 m0, 160768
  s_nop 0
  buffer_load_dwordx4 v6, s[4:7], s72 offen nt lds
  s_add_u32 s72, s72, 8192
  s_mov_b32 m0, 161792
  s_nop 0
  buffer_load_dwordx4 v6, s[4:7], s72 offen nt lds
  s_waitcnt vmcnt(8)
  ds_write_b32 v15, v15 offset:144
  s_waitcnt vmcnt(0)
  ds_read_b64_tr_b16 v[80:81], v1 offset:0
  ds_read_b64_tr_b16 v[82:83], v1 offset:512
  ds_read_b64_tr_b16 v[84:85], v1 offset:4096
  ds_read_b64_tr_b16 v[86:87], v1 offset:4608
  ds_read_b64_tr_b16 v[88:89], v1 offset:32
  ds_read_b64_tr_b16 v[90:91], v1 offset:544
  ds_read_b64_tr_b16 v[92:93], v1 offset:4128
  ds_read_b64_tr_b16 v[94:95], v1 offset:4640
  ds_read_b64_tr_b16 v[96:97], v1 offset:64
  ds_read_b64_tr_b16 v[98:99], v1 offset:576
  ds_read_b64_tr_b16 v[100:101], v1 offset:4160
  ds_read_b64_tr_b16 v[102:103], v1 offset:4672
  ds_read_b64_tr_b16 v[104:105], v1 offset:96
  ds_read_b64_tr_b16 v[106:107], v1 offset:608
  ds_read_b64_tr_b16 v[108:109], v1 offset:4192
  ds_read_b64_tr_b16 v[110:111], v1 offset:4704
  s_waitcnt lgkmcnt(0)
  v_mfma_f32_16x16x32_bf16 v[112:115], v[80:83], v[48:51], 0
  v_mfma_f32_16x16x32_bf16 v[112:115], v[84:87], v[52:55], v[112:115]
  v_mfma_f32_16x16x32_bf16 v[116:119], v[88:91], v[48:51], 0
  v_mfma_f32_16x16x32_bf16 v[116:119], v[92:95], v[52:55], v[116:119]
  v_mfma_f32_16x16x32_bf16 v[120:123], v[96:99], v[48:51], 0
  v_mfma_f32_16x16x32_bf16 v[120:123], v[100:103], v[52:55], v[120:123]
  v_mfma_f32_16x16x32_bf16 v[124:127], v[104:107], v[48:51], 0
  v_mfma_f32_16x16x32_bf16 v[124:127], v[108:111], v[52:55], v[124:127]
  s_nop 1
  v_perm_b32 v112, v112, v166, s42
  v_perm_b32 v113, v113, v166, s43
  v_perm_b32 v114, v114, v166, s44
  v_perm_b32 v115, v115, v166, s45
  v_perm_b32 v116, v116, v166, s42
  v_perm_b32 v117, v117, v166, s43
  v_perm_b32 v118, v118, v166, s44
  v_perm_b32 v119, v119, v166, s45
  v_perm_b32 v120, v120, v166, s42
  v_perm_b32 v121, v121, v166, s43
  v_perm_b32 v122, v122, v166, s44
  v_perm_b32 v123, v123, v166, s45
  v_perm_b32 v124, v124, v166, s42
  v_perm_b32 v125, v125, v166, s43
  v_perm_b32 v126, v126, v166, s44
  v_perm_b32 v127, v127, v166, s45
  s_mov_b64 exec, s[58:59]
  s_cmp_eq_u32 s28, 1
  s_cbranch_scc1 L_ldn
  buffer_store_dwordx4 v[112:115], v14, s[12:15], s75 offen sc1
  s_add_u32 s75, s75, 32768
  buffer_store_dwordx4 v[116:119], v14, s[12:15], s75 offen sc1
  s_add_u32 s75, s75, 32768
  buffer_store_dwordx4 v[120:123], v14, s[12:15], s75 offen sc1
  s_add_u32 s75, s75, 32768
  buffer_store_dwordx4 v[124:127], v14, s[12:15], s75 offen sc1
  s_branch L_ldd
L_ldn:
  buffer_store_dwordx4 v[112:115], v14, s[12:15], s75 offen
  s_add_u32 s75, s75, 32768
  buffer_store_dwordx4 v[116:119], v14, s[12:15], s75 offen
  s_add_u32 s75, s75, 32768
  buffer_store_dwordx4 v[120:123], v14, s[12:15], s75 offen
  s_add_u32 s75, s75, 32768
  buffer_store_dwordx4 v[124:127], v14, s[12:15], s75 offen
L_ldd:
  s_mov_b64 exec, -1
  s_endpgm
  s_waitcnt vmcnt(0) lgkmcnt(0)
  s_endpgm
L_stream:
  s_add_u32 s26, s22, 32
  s_and_b32 s26, s26, 511
  s_lshl_b32 s26, s26, 12
  s_add_u32 s26, s26, s21
  s_mov_b32 m0, s24
  s_mov_b32 s8, s36
  s_mov_b32 s9, s37
  s_mov_b32 s10, 0x8000000
  s_mov_b32 s11, 0x00020000
  s_mov_b32 s12, s56
  s_mov_b32 s13, s57
  s_mov_b32 s14, 0x500000
  s_mov_b32 s15, 0x00020000
  v_lshrrev_b32 v19, 1, v22
  v_add_u32 v40, 0, v23
  v_xor_b32 v19, v19, v40
  v_lshlrev_b32 v19, 5, v19
  v_and_b32 v40, 1, v22
  v_lshl_add_u32 v19, v40, 4, v19
  v_lshl_add_u32 v5, v23, 8, v19
  v_lshrrev_b32 v19, 1, v22
  v_add_u32 v40, 4, v23
  v_xor_b32 v19, v19, v40
  v_lshlrev_b32 v19, 5, v19
  v_and_b32 v40, 1, v22
  v_lshl_add_u32 v19, v40, 4, v19
  v_lshl_add_u32 v6, v23, 8, v19
  s_mov_b32 s79, 0x7f817f81
  v_mov_b32 v56, s79
  v_mov_b32 v57, s79
  v_mov_b32 v58, s79
  v_mov_b32 v59, s79
  s_mul_i32 s25, s3, 2048
  s_add_u32 s25, s25, 98304
  v_lshl_add_u32 v19, v0, 4, s25
  ds_write_b128 v19, v[56:59] offset:0
  ds_write_b128 v19, v[56:59] offset:1024
  v_lshrrev_b32 v40, 2, v0
  v_and_b32 v41, 7, v40
  v_and_b32 v42, 3, v0
  v_lshlrev_b32 v42, 3, v42
  v_lshl_add_u32 v68, v23, 5, v42
  v_add_u32 v68, 98304, v68
  v_lshl_add_u32 v42, v40, 8, v42
  v_xor_b32 v43, 0, v41
  v_lshl_add_u32 v11, v43, 5, v42
  v_xor_b32 v43, 1, v41
  v_lshl_add_u32 v12, v43, 5, v42
  v_xor_b32 v43, 2, v41
  v_lshl_add_u32 v13, v43, 5, v42
  v_xor_b32 v43, 3, v41
  v_lshl_add_u32 v14, v43, 5, v42
  v_xor_b32 v43, 4, v41
  v_lshl_add_u32 v15, v43, 5, v42
  v_xor_b32 v43, 5, v41
  v_lshl_add_u32 v16, v43, 5, v42
  v_xor_b32 v43, 6, v41
  v_lshl_add_u32 v17, v43, 5, v42
  v_xor_b32 v43, 7, v41
  v_lshl_add_u32 v18, v43, 5, v42
  v_cmp_gt_u32 s[70:71], 8, v22
  v_mov_b32 v20, 0xf149f2ca
  v_mov_b32 v21, 0
  v_mov_b32 v65, 0x7191accb
  s_mov_b32 s68, 0x000f000f
  s_mov_b32 s69, s68
  v_mov_b32 v71, 0
  s_mov_b32 s58, 0x3db504f3
  s_mov_b32 s59, 0x3fb8aa3b
  s_mov_b32 s31, 0xbfb8aa3b
  v_mov_b32 v63, 1
  v_mov_b32 v64, 149632
  v_mov_b32 v69, 149632
  s_mov_b32 s78, 152576
  s_mov_b32 s96, 0
  s_mov_b32 s60, s24
  s_add_u32 s61, s24, 4096
  s_add_u32 s72, s24, 8192
  s_lshl_b32 s73, s3, 7
  s_xor_b32 s27, s73, 1024
  s_xor_b32 s28, s73, 2048
  s_mov_b32 s42, 0x7060500
  s_mov_b32 s43, 0x7060501
  s_mov_b32 s44, 0x7060502
  s_mov_b32 s45, 0x7060503
  s_mov_b32 s46, 0x0c0c0400
  s_mov_b32 s47, 0x04000c0c
  v_mov_b32 v72, 0
  v_mov_b32 v73, 0
  v_mov_b32 v74, 0
  v_mov_b32 v75, 0
  v_mov_b32 v76, 0
  v_mov_b32 v77, 0
  v_mov_b32 v78, 0
  v_mov_b32 v79, 0
  v_mov_b32 v80, 0
  v_mov_b32 v81, 0
  v_mov_b32 v82, 0
  v_mov_b32 v83, 0
  v_mov_b32 v84, 0
  v_mov_b32 v85, 0
  v_mov_b32 v86, 0
  v_mov_b32 v87, 0
  v_mov_b32 v24, 0
  v_mov_b32 v25, 0
  v_mov_b32 v26, 0
  v_mov_b32 v27, 0
  v_mov_b32 v28, 0
  v_mov_b32 v29, 0
  v_mov_b32 v30, 0
  v_mov_b32 v31, 0
  v_mov_b32 v32, 0
  v_mov_b32 v33, 0
  v_mov_b32 v34, 0
  v_mov_b32 v35, 0
  v_mov_b32 v36, 0
  v_mov_b32 v37, 0
  v_mov_b32 v38, 0
  v_mov_b32 v39, 0
  s_waitcnt lgkmcnt(0)
  s_barrier
  buffer_load_dwordx4 v1, s[4:7], s26 offen offset:0 nt lds
  buffer_load_dwordx4 v2, s[4:7], s26 offen offset:1024 nt lds
  buffer_load_dwordx4 v3, s[4:7], s26 offen offset:2048 nt lds
  buffer_load_dwordx4 v4, s[4:7], s26 offen offset:3072 nt lds
  s_add_u32 s26, s22, 64
  s_and_b32 s26, s26, 511
  s_lshl_b32 s26, s26, 12
  s_add_u32 s26, s26, s21
  s_add_u32 m0, s24, 4096
  s_waitcnt vmcnt(7)
  buffer_load_dwordx4 v1, s[4:7], s26 offen offset:0 nt lds
  s_waitcnt vmcnt(7)
  buffer_load_dwordx4 v2, s[4:7], s26 offen offset:1024 nt lds
  s_waitcnt vmcnt(7)
  buffer_load_dwordx4 v3, s[4:7], s26 offen offset:2048 nt lds
  s_waitcnt vmcnt(7)
  buffer_load_dwordx4 v4, s[4:7], s26 offen offset:3072 nt lds
  s_add_u32 s26, s22, 96
  s_and_b32 s26, s26, 511
  s_lshl_b32 s26, s26, 12
  s_add_u32 s26, s26, s21
  s_waitcnt vmcnt(7)
  buffer_load_dwordx4 v[88:91], v1, s[4:7], s26 offen offset:0 nt
  s_waitcnt vmcnt(7)
  buffer_load_dwordx4 v[92:95], v2, s[4:7], s26 offen offset:1024 nt
  s_waitcnt vmcnt(7)
  buffer_load_dwordx4 v[96:99], v3, s[4:7], s26 offen offset:2048 nt
  s_waitcnt vmcnt(7)
  buffer_load_dwordx4 v[100:103], v4, s[4:7], s26 offen offset:3072 nt
  s_add_u32 s26, s22, 128
  s_and_b32 s26, s26, 511
  s_lshl_b32 s26, s26, 12
  s_add_u32 s26, s26, s21
  s_waitcnt vmcnt(7)
  buffer_load_dwordx4 v[104:107], v1, s[4:7], s26 offen offset:0 nt
  s_waitcnt vmcnt(7)
  buffer_load_dwordx4 v[108:111], v2, s[4:7], s26 offen offset:1024 nt
  s_waitcnt vmcnt(7)
  buffer_load_dwordx4 v[112:115], v3, s[4:7], s26 offen offset:2048 nt
  s_waitcnt vmcnt(7)
  buffer_load_dwordx4 v[116:119], v4, s[4:7], s26 offen offset:3072 nt
  s_add_u32 s26, s22, 160
  s_and_b32 s26, s26, 511
  s_lshl_b32 s26, s26, 12
  s_add_u32 s26, s26, s21
  s_waitcnt vmcnt(7)
  buffer_load_dwordx4 v[120:123], v1, s[4:7], s26 offen offset:0 nt
  s_waitcnt vmcnt(7)
  buffer_load_dwordx4 v[124:127], v2, s[4:7], s26 offen offset:1024 nt
  s_waitcnt vmcnt(7)
  buffer_load_dwordx4 v[128:131], v3, s[4:7], s26 offen offset:2048 nt
  s_waitcnt vmcnt(7)
  buffer_load_dwordx4 v[132:135], v4, s[4:7], s26 offen offset:3072 nt
  s_add_u32 s26, s22, 192
  s_and_b32 s26, s26, 511
  s_lshl_b32 s26, s26, 12
  s_add_u32 s26, s26, s21
  s_waitcnt vmcnt(7)
  buffer_load_dwordx4 v[136:139], v1, s[4:7], s26 offen offset:0 nt
  s_waitcnt vmcnt(7)
  buffer_load_dwordx4 v[140:143], v2, s[4:7], s26 offen offset:1024 nt
  s_waitcnt vmcnt(7)
  buffer_load_dwordx4 v[144:147], v3, s[4:7], s26 offen offset:2048 nt
  s_waitcnt vmcnt(7)
  buffer_load_dwordx4 v[148:151], v4, s[4:7], s26 offen offset:3072 nt
  s_add_u32 s26, s22, 224
  s_and_b32 s26, s26, 511
  s_lshl_b32 s26, s26, 12
  s_add_u32 s26, s26, s21
  s_waitcnt vmcnt(7)
  buffer_load_dwordx4 v[152:155], v1, s[4:7], s26 offen offset:0 nt
  s_waitcnt vmcnt(7)
  buffer_load_dwordx4 v[156:159], v2, s[4:7], s26 offen offset:1024 nt
  s_waitcnt vmcnt(7)
  buffer_load_dwordx4 v[160:163], v3, s[4:7], s26 offen offset:2048 nt
  s_waitcnt vmcnt(7)
  buffer_load_dwordx4 v[164:167], v4, s[4:7], s26 offen offset:3072 nt
  v_lshlrev_b32 v19, 4, v23
  v_lshl_add_u32 v19, v22, 8, v19
  v_add_u32 v19, 147456, v19
  s_mov_b32 s76, 1048576
L_qw:
  ds_read_b32 v60, v64 offset:4
  s_waitcnt lgkmcnt(0)
  v_cmp_ne_u32 vcc, 1, v60
  s_sub_u32 s76, s76, 1
  s_cmp_eq_u32 s76, 0
  s_cbranch_scc1 L_qwdone
  s_cmp_eq_u64 vcc, 0
  s_cbranch_scc1 L_qwdone
  s_sleep 1
  s_branch L_qw
L_qwdone:
  s_mov_b32 exec_lo, 0x000f000f
  s_mov_b32 exec_hi, 0x000f000f
  ds_read_b128 v[24:27], v19 offset:0
  ds_read_b128 v[28:31], v19 offset:64
  ds_read_b128 v[32:35], v19 offset:128
  ds_read_b128 v[36:39], v19 offset:192
  s_mov_b64 exec, -1
  s_mov_b32 s76, 4194304
  s_waitcnt vmcnt(28)
  s_mov_b32 s97, 0
  s_mov_b64 exec, 1
  ds_add_rtn_u32 v62, v69, v63
  s_mov_b64 exec, -1
  v_add_u32 v40, s72, v7
  ds_read_b128 v[40:43], v40
  v_add_u32 v44, s72, v8
  ds_read_b128 v[44:47], v44
  v_add_u32 v48, s72, v9
  ds_read_b128 v[48:51], v48
  v_add_u32 v52, s72, v10
  ds_read_b128 v[52:55], v52
  s_andn2_b32 s25, s73, 127
  v_add_u32 v19, s25, v68
  s_waitcnt lgkmcnt(4)
  v_readfirstlane_b32 s25, v62
  s_and_b32 s75, s25, 1
  s_lshr_b32 s25, s25, 1
  s_lshl2_add_u32 s25, s25, s78
  v_mov_b32 v70, s25
  s_waitcnt lgkmcnt(3)
  v_mfma_f32_16x16x32_bf16 v[56:59], v[40:43], v[24:27], 0
  s_waitcnt lgkmcnt(2)
  v_mfma_f32_16x16x32_bf16 v[56:59], v[44:47], v[28:31], v[56:59]
  s_waitcnt lgkmcnt(1)
  v_mfma_f32_16x16x32_bf16 v[56:59], v[48:51], v[32:35], v[56:59]
  s_waitcnt lgkmcnt(0)
  v_mfma_f32_16x16x32_bf16 v[56:59], v[52:55], v[36:39], v[56:59]
  s_nop 7
  v_cvt_pk_bf16_f32 v60, v56, v57
  v_cvt_pk_bf16_f32 v61, v58, v59
  v_lshlrev_b32 v56, 16, v60
  v_and_b32 v57, 0xffff0000, v60
  v_lshlrev_b32 v58, 16, v61
  v_and_b32 v59, 0xffff0000, v61
  v_mul_f32 v56, s58, v56
  v_mul_f32 v57, s58, v57
  v_mul_f32 v58, s58, v58
  v_mul_f32 v59, s58, v59
  v_cvt_pk_bf16_f32 v66, v56, v57
  v_cvt_pk_bf16_f32 v67, v58, v59
  s_mov_b64 exec, s[68:69]
  ds_write_b64 v19, v[66:67]
  s_mov_b64 exec, -1
  ds_read_b32 v62, v70
L_loop:
  s_cmp_eq_u32 s96, 2
  s_cbranch_scc1 L_flush
  s_branch L_loop2
L_pre:
  s_bitcmp1_b32 s27, 0
  s_cbranch_scc0 L_loop2
  s_andn2_b32 s25, s27, 127
  v_add_u32 v19, s25, v68
  ds_read_b64 v[66:67], v19
  s_waitcnt lgkmcnt(0)
L_sr1:
  v_cmp_eq_u32 vcc, s79, v66
  s_cbranch_vccnz L_loop2
  v_cmp_eq_u32 vcc, s79, v67
  s_cbranch_vccnz L_loop2
L_sg1:
  v_lshlrev_b32 v56, 16, v66
  v_and_b32 v57, 0xffff0000, v66
  v_lshlrev_b32 v58, 16, v67
  v_and_b32 v59, 0xffff0000, v67
  v_max3_f32 v60, v56, v57, v58
  v_max3_f32 v60, v60, v59, v20
  v_cmp_gt_f32 vcc, v60, v20
  s_cbranch_vccz L_nr1
  v_mov_b32 v61, v60
  s_nop 1
  v_permlane16_swap_b32 v60, v61
  v_max_f32 v60, v60, v61
  v_mov_b32 v61, v60
  s_nop 1
  v_permlane32_swap_b32 v60, v61
  v_max_f32 v60, v60, v61
  v_sub_f32 v61, v20, v60
  v_mul_f32 v61, s59, v61
  v_exp_f32 v61, v61
  v_mov_b32 v20, v60
  v_mul_f32 v65, s31, v60
  v_mul_f32 v21, v21, v61
  v_mul_f32 v72, v72, v61
  v_mul_f32 v73, v73, v61
  v_mul_f32 v74, v74, v61
  v_mul_f32 v75, v75, v61
  v_mul_f32 v76, v76, v61
  v_mul_f32 v77, v77, v61
  v_mul_f32 v78, v78, v61
  v_mul_f32 v79, v79, v61
  v_mul_f32 v80, v80, v61
  v_mul_f32 v81, v81, v61
  v_mul_f32 v82, v82, v61
  v_mul_f32 v83, v83, v61
  v_mul_f32 v84, v84, v61
  v_mul_f32 v85, v85, v61
  v_mul_f32 v86, v86, v61
  v_mul_f32 v87, v87, v61
  v_mul_f32 v88, v88, v61
  v_mul_f32 v89, v89, v61
  v_mul_f32 v90, v90, v61
  v_mul_f32 v91, v91, v61
  v_mul_f32 v92, v92, v61
  v_mul_f32 v93, v93, v61
  v_mul_f32 v94, v94, v61
  v_mul_f32 v95, v95, v61
  v_mul_f32 v96, v96, v61
  v_mul_f32 v97, v97, v61
  v_mul_f32 v98, v98, v61
  v_mul_f32 v99, v99, v61
  v_mul_f32 v100, v100, v61
  v_mul_f32 v101, v101, v61
  v_mul_f32 v102, v102, v61
  v_mul_f32 v103, v103, v61
L_nr1:
  v_fma_f32 v56, v56, s59, v65
  v_fma_f32 v57, v57, s59, v65
  v_fma_f32 v58, v58, s59, v65
  v_fma_f32 v59, v59, s59, v65
  v_exp_f32 v56, v56
  v_exp_f32 v57, v57
  v_exp_f32 v58, v58
  v_exp_f32 v59, v59
  v_cvt_pk_bf16_f32 v66, v56, v57
  v_cvt_pk_bf16_f32 v67, v58, v59
  v_add_f32 v60, v56, v57
  v_add_f32 v61, v58, v59
  v_add_f32 v60, v60, v61
  v_add_f32 v21, v21, v60
  s_or_b32 s27, s27, 2
L_loop2:
  s_waitcnt vmcnt(4) lgkmcnt(0)
L_eretry:
  v_readfirstlane_b32 s23, v62
  s_mov_b32 m0, s72
  s_cmp_eq_u32 s23, -1
  s_cbranch_scc1 L_espin
  s_bitcmp1_b32 s23, 9
  s_cbranch_scc1 L_special
  s_lshl1_add_u32 s26, s23, s75
  s_add_u32 s26, s26, s77
  s_and_b32 s26, s26, 511
  s_lshl_b32 s26, s26, 12
  s_add_u32 s26, s26, s21
  s_bitcmp1_b32 s23, 15
  s_cbranch_scc1 L_isv
  buffer_load_dwordx4 v1, s[4:7], s26 offen offset:0 nt lds
  buffer_load_dwordx4 v2, s[4:7], s26 offen offset:1024 nt lds
  buffer_load_dwordx4 v3, s[4:7], s26 offen offset:2048 nt lds
  buffer_load_dwordx4 v4, s[4:7], s26 offen offset:3072 nt lds
  s_branch L_isd
L_isv:
  buffer_load_dwordx4 v5, s[8:11], s26 offen offset:0 nt lds
  buffer_load_dwordx4 v6, s[8:11], s26 offen offset:1024 nt lds
  buffer_load_dwordx4 v5, s[8:11], s26 offen offset:2048 nt lds
  buffer_load_dwordx4 v6, s[8:11], s26 offen offset:3072 nt lds
L_isd:
  s_bfe_u32 s73, s23, 0x1000f
  s_lshr_b32 s23, s23, 16
  s_lshl1_add_u32 s23, s23, s75
  s_lshl_b32 s23, s23, 7
  s_or_b32 s73, s73, s23
L_proc:
  s_mov_b64 exec, 1
  ds_add_rtn_u32 v62, v69, v63
  s_mov_b64 exec, -1
  s_bitcmp1_b32 s27, 0
  s_cbranch_scc1 L_pv
  v_add_u32 v40, s60, v7
  ds_read_b128 v[40:43], v40
  v_add_u32 v44, s60, v8
  ds_read_b128 v[44:47], v44
  v_add_u32 v48, s60, v9
  ds_read_b128 v[48:51], v48
  v_add_u32 v52, s60, v10
  ds_read_b128 v[52:55], v52
  s_andn2_b32 s25, s27, 127
  v_add_u32 v19, s25, v68
  s_waitcnt lgkmcnt(4)
  v_readfirstlane_b32 s25, v62
  s_and_b32 s75, s25, 1
  s_lshr_b32 s25, s25, 1
  s_lshl2_add_u32 s25, s25, s78
  v_mov_b32 v70, s25
  s_waitcnt lgkmcnt(3)
  v_mfma_f32_16x16x32_bf16 v[56:59], v[40:43], v[24:27], 0
  s_waitcnt lgkmcnt(2)
  v_mfma_f32_16x16x32_bf16 v[56:59], v[44:47], v[28:31], v[56:59]
  s_waitcnt lgkmcnt(1)
  v_mfma_f32_16x16x32_bf16 v[56:59], v[48:51], v[32:35], v[56:59]
  s_waitcnt lgkmcnt(0)
  v_mfma_f32_16x16x32_bf16 v[56:59], v[52:55], v[36:39], v[56:59]
  s_nop 7
  v_cvt_pk_bf16_f32 v60, v56, v57
  v_cvt_pk_bf16_f32 v61, v58, v59
  v_lshlrev_b32 v56, 16, v60
  v_and_b32 v57, 0xffff0000, v60
  v_lshlrev_b32 v58, 16, v61
  v_and_b32 v59, 0xffff0000, v61
  v_mul_f32 v56, s58, v56
  v_mul_f32 v57, s58, v57
  v_mul_f32 v58, s58, v58
  v_mul_f32 v59, s58, v59
  v_cvt_pk_bf16_f32 v66, v56, v57
  v_cvt_pk_bf16_f32 v67, v58, v59
  s_mov_b64 exec, s[68:69]
  ds_write_b64 v19, v[66:67]
  s_mov_b64 exec, -1
  s_branch L_pd
L_pv:
  s_bitcmp1_b32 s27, 1
  s_cbranch_scc0 L_pv1
  v_add_u32 v40, s60, v11
  ds_read_b64_tr_b16 v[40:41], v40
  v_add_u32 v42, s60, v12
  ds_read_b64_tr_b16 v[42:43], v42
  v_add_u32 v44, s60, v13
  ds_read_b64_tr_b16 v[44:45], v44
  v_add_u32 v46, s60, v14
  ds_read_b64_tr_b16 v[46:47], v46
  v_add_u32 v48, s60, v15
  ds_read_b64_tr_b16 v[48:49], v48
  v_add_u32 v50, s60, v16
  ds_read_b64_tr_b16 v[50:51], v50
  v_add_u32 v52, s60, v17
  ds_read_b64_tr_b16 v[52:53], v52
  v_add_u32 v54, s60, v18
  ds_read_b64_tr_b16 v[54:55], v54
  s_waitcnt lgkmcnt(8)
  v_readfirstlane_b32 s25, v62
  s_and_b32 s75, s25, 1
  s_lshr_b32 s25, s25, 1
  s_lshl2_add_u32 s25, s25, s78
  v_mov_b32 v70, s25
  ds_read_b32 v62, v70
  s_waitcnt lgkmcnt(8)
  v_mfma_f32_16x16x16_bf16 v[72:75], v[40:41], v[66:67], v[72:75]
  s_waitcnt lgkmcnt(7)
  v_mfma_f32_16x16x16_bf16 v[76:79], v[42:43], v[66:67], v[76:79]
  s_waitcnt lgkmcnt(6)
  v_mfma_f32_16x16x16_bf16 v[80:83], v[44:45], v[66:67], v[80:83]
  s_waitcnt lgkmcnt(5)
  v_mfma_f32_16x16x16_bf16 v[84:87], v[46:47], v[66:67], v[84:87]
  s_waitcnt lgkmcnt(4)
  v_mfma_f32_16x16x16_bf16 v[88:91], v[48:49], v[66:67], v[88:91]
  s_waitcnt lgkmcnt(3)
  v_mfma_f32_16x16x16_bf16 v[92:95], v[50:51], v[66:67], v[92:95]
  s_waitcnt lgkmcnt(2)
  v_mfma_f32_16x16x16_bf16 v[96:99], v[52:53], v[66:67], v[96:99]
  s_waitcnt lgkmcnt(1)
  v_mfma_f32_16x16x16_bf16 v[100:103], v[54:55], v[66:67], v[100:103]
  s_branch L_pd2
L_pd:
  ds_read_b32 v62, v70
L_pd2:
  s_mov_b32 s25, s60
  s_mov_b32 s60, s61
  s_mov_b32 s61, s72
  s_mov_b32 s72, s25
  s_mov_b32 s27, s28
  s_mov_b32 s28, s73
  s_add_u32 s96, s96, 1
  s_cmp_eq_u32 s97, 1
  s_cbranch_scc1 L_pre
  s_cmp_lt_u32 s97, 2
  s_cbranch_scc1 L_loop
  s_cmp_eq_u32 s97, 3
  s_cbranch_scc1 L_final
L_flush0:
  s_waitcnt vmcnt(0)
L_flush:
  s_waitcnt vmcnt(8)
  v_lshlrev_b32 v66, 4, v0
  v_add_u32 v71, s72, v66
  s_lshl_b32 s73, s3, 7
  ds_write_b128 v71, v[88:91] offset:0
  ds_write_b128 v71, v[92:95] offset:1024
  ds_write_b128 v71, v[96:99] offset:2048
  ds_write_b128 v71, v[100:103] offset:3072
  s_xor_b32 s23, s73, 3072
  v_add_u32 v40, s72, v7
  ds_read_b128 v[40:43], v40
  v_add_u32 v44, s72, v8
  ds_read_b128 v[44:47], v44
  v_add_u32 v48, s72, v9
  ds_read_b128 v[48:51], v48
  v_add_u32 v52, s72, v10
  ds_read_b128 v[52:55], v52
  s_andn2_b32 s25, s23, 127
  v_add_u32 v19, s25, v68
  s_waitcnt lgkmcnt(3)
  v_mfma_f32_16x16x32_bf16 v[56:59], v[40:43], v[24:27], 0
  s_waitcnt lgkmcnt(2)
  v_mfma_f32_16x16x32_bf16 v[56:59], v[44:47], v[28:31], v[56:59]
  s_waitcnt lgkmcnt(1)
  v_mfma_f32_16x16x32_bf16 v[56:59], v[48:51], v[32:35], v[56:59]
  s_waitcnt lgkmcnt(0)
  v_mfma_f32_16x16x32_bf16 v[56:59], v[52:55], v[36:39], v[56:59]
  s_nop 7
  v_cvt_pk_bf16_f32 v60, v56, v57
  v_cvt_pk_bf16_f32 v61, v58, v59
  v_lshlrev_b32 v56, 16, v60
  v_and_b32 v57, 0xffff0000, v60
  v_lshlrev_b32 v58, 16, v61
  v_and_b32 v59, 0xffff0000, v61
  v_mul_f32 v56, s58, v56
  v_mul_f32 v57, s58, v57
  v_mul_f32 v58, s58, v58
  v_mul_f32 v59, s58, v59
  v_cvt_pk_bf16_f32 v66, v56, v57
  v_cvt_pk_bf16_f32 v67, v58, v59
  s_mov_b64 exec, s[68:69]
  ds_write_b64 v19, v[66:67]
  s_mov_b64 exec, -1
  ds_write_b128 v71, v[104:107] offset:0
  ds_write_b128 v71, v[108:111] offset:1024
  ds_write_b128 v71, v[112:115] offset:2048
  ds_write_b128 v71, v[116:119] offset:3072
  s_xor_b32 s23, s73, 4096
  v_add_u32 v40, s72, v7
  ds_read_b128 v[40:43], v40
  v_add_u32 v44, s72, v8
  ds_read_b128 v[44:47], v44
  v_add_u32 v48, s72, v9
  ds_read_b128 v[48:51], v48
  v_add_u32 v52, s72, v10
  ds_read_b128 v[52:55], v52
  s_andn2_b32 s25, s23, 127
  v_add_u32 v19, s25, v68
  s_waitcnt lgkmcnt(3)
  v_mfma_f32_16x16x32_bf16 v[56:59], v[40:43], v[24:27], 0
  s_waitcnt lgkmcnt(2)
  v_mfma_f32_16x16x32_bf16 v[56:59], v[44:47], v[28:31], v[56:59]
  s_waitcnt lgkmcnt(1)
  v_mfma_f32_16x16x32_bf16 v[56:59], v[48:51], v[32:35], v[56:59]
  s_waitcnt lgkmcnt(0)
  v_mfma_f32_16x16x32_bf16 v[56:59], v[52:55], v[36:39], v[56:59]
  s_nop 7
  v_cvt_pk_bf16_f32 v60, v56, v57
  v_cvt_pk_bf16_f32 v61, v58, v59
  v_lshlrev_b32 v56, 16, v60
  v_and_b32 v57, 0xffff0000, v60
  v_lshlrev_b32 v58, 16, v61
  v_and_b32 v59, 0xffff0000, v61
  v_mul_f32 v56, s58, v56
  v_mul_f32 v57, s58, v57
  v_mul_f32 v58, s58, v58
  v_mul_f32 v59, s58, v59
  v_cvt_pk_bf16_f32 v66, v56, v57
  v_cvt_pk_bf16_f32 v67, v58, v59
  s_mov_b64 exec, s[68:69]
  ds_write_b64 v19, v[66:67]
  s_mov_b64 exec, -1
  ds_write_b128 v71, v[120:123] offset:0
  ds_write_b128 v71, v[124:127] offset:1024
  ds_write_b128 v71, v[128:131] offset:2048
  ds_write_b128 v71, v[132:135] offset:3072
  s_xor_b32 s23, s73, 5120
  v_add_u32 v40, s72, v7
  ds_read_b128 v[40:43], v40
  v_add_u32 v44, s72, v8
  ds_read_b128 v[44:47], v44
  v_add_u32 v48, s72, v9
  ds_read_b128 v[48:51], v48
  v_add_u32 v52, s72, v10
  ds_read_b128 v[52:55], v52
  s_andn2_b32 s25, s23, 127
  v_add_u32 v19, s25, v68
  s_waitcnt lgkmcnt(3)
  v_mfma_f32_16x16x32_bf16 v[56:59], v[40:43], v[24:27], 0
  s_waitcnt lgkmcnt(2)
  v_mfma_f32_16x16x32_bf16 v[56:59], v[44:47], v[28:31], v[56:59]
  s_waitcnt lgkmcnt(1)
  v_mfma_f32_16x16x32_bf16 v[56:59], v[48:51], v[32:35], v[56:59]
  s_waitcnt lgkmcnt(0)
  v_mfma_f32_16x16x32_bf16 v[56:59], v[52:55], v[36:39], v[56:59]
  s_nop 7
  v_cvt_pk_bf16_f32 v60, v56, v57
  v_cvt_pk_bf16_f32 v61, v58, v59
  v_lshlrev_b32 v56, 16, v60
  v_and_b32 v57, 0xffff0000, v60
  v_lshlrev_b32 v58, 16, v61
  v_and_b32 v59, 0xffff0000, v61
  v_mul_f32 v56, s58, v56
  v_mul_f32 v57, s58, v57
  v_mul_f32 v58, s58, v58
  v_mul_f32 v59, s58, v59
  v_cvt_pk_bf16_f32 v66, v56, v57
  v_cvt_pk_bf16_f32 v67, v58, v59
  s_mov_b64 exec, s[68:69]
  ds_write_b64 v19, v[66:67]
  s_mov_b64 exec, -1
  ds_write_b128 v71, v[136:139] offset:0
  ds_write_b128 v71, v[140:143] offset:1024
  ds_write_b128 v71, v[144:147] offset:2048
  ds_write_b128 v71, v[148:151] offset:3072
  s_xor_b32 s23, s73, 6144
  v_add_u32 v40, s72, v7
  ds_read_b128 v[40:43], v40
  v_add_u32 v44, s72, v8
  ds_read_b128 v[44:47], v44
  v_add_u32 v48, s72, v9
  ds_read_b128 v[48:51], v48
  v_add_u32 v52, s72, v10
  ds_read_b128 v[52:55], v52
  s_andn2_b32 s25, s23, 127
  v_add_u32 v19, s25, v68
  s_waitcnt lgkmcnt(3)
  v_mfma_f32_16x16x32_bf16 v[56:59], v[40:43], v[24:27], 0
  s_waitcnt lgkmcnt(2)
  v_mfma_f32_16x16x32_bf16 v[56:59], v[44:47], v[28:31], v[56:59]
  s_waitcnt lgkmcnt(1)
  v_mfma_f32_16x16x32_bf16 v[56:59], v[48:51], v[32:35], v[56:59]
  s_waitcnt lgkmcnt(0)
  v_mfma_f32_16x16x32_bf16 v[56:59], v[52:55], v[36:39], v[56:59]
  s_nop 7
  v_cvt_pk_bf16_f32 v60, v56, v57
  v_cvt_pk_bf16_f32 v61, v58, v59
  v_lshlrev_b32 v56, 16, v60
  v_and_b32 v57, 0xffff0000, v60
  v_lshlrev_b32 v58, 16, v61
  v_and_b32 v59, 0xffff0000, v61
  v_mul_f32 v56, s58, v56
  v_mul_f32 v57, s58, v57
  v_mul_f32 v58, s58, v58
  v_mul_f32 v59, s58, v59
  v_cvt_pk_bf16_f32 v66, v56, v57
  v_cvt_pk_bf16_f32 v67, v58, v59
  s_mov_b64 exec, s[68:69]
  ds_write_b64 v19, v[66:67]
  s_mov_b64 exec, -1
  ds_write_b128 v71, v[152:155] offset:0
  ds_write_b128 v71, v[156:159] offset:1024
  ds_write_b128 v71, v[160:163] offset:2048
  ds_write_b128 v71, v[164:167] offset:3072
  s_xor_b32 s23, s73, 7168
  v_add_u32 v40, s72, v7
  ds_read_b128 v[40:43], v40
  v_add_u32 v44, s72, v8
  ds_read_b128 v[44:47], v44
  v_add_u32 v48, s72, v9
  ds_read_b128 v[48:51], v48
  v_add_u32 v52, s72, v10
  ds_read_b128 v[52:55], v52
  s_andn2_b32 s25, s23, 127
  v_add_u32 v19, s25, v68
  s_waitcnt lgkmcnt(3)
  v_mfma_f32_16x16x32_bf16 v[56:59], v[40:43], v[24:27], 0
  s_waitcnt lgkmcnt(2)
  v_mfma_f32_16x16x32_bf16 v[56:59], v[44:47], v[28:31], v[56:59]
  s_waitcnt lgkmcnt(1)
  v_mfma_f32_16x16x32_bf16 v[56:59], v[48:51], v[32:35], v[56:59]
  s_waitcnt lgkmcnt(0)
  v_mfma_f32_16x16x32_bf16 v[56:59], v[52:55], v[36:39], v[56:59]
  s_nop 7
  v_cvt_pk_bf16_f32 v60, v56, v57
  v_cvt_pk_bf16_f32 v61, v58, v59
  v_lshlrev_b32 v56, 16, v60
  v_and_b32 v57, 0xffff0000, v60
  v_lshlrev_b32 v58, 16, v61
  v_and_b32 v59, 0xffff0000, v61
  v_mul_f32 v56, s58, v56
  v_mul_f32 v57, s58, v57
  v_mul_f32 v58, s58, v58
  v_mul_f32 v59, s58, v59
  v_cvt_pk_bf16_f32 v66, v56, v57
  v_cvt_pk_bf16_f32 v67, v58, v59
  s_mov_b64 exec, s[68:69]
  ds_write_b64 v19, v[66:67]
  s_mov_b64 exec, -1
  v_mov_b32 v71, 0
  v_mov_b32 v88, 0
  v_mov_b32 v89, 0
  v_mov_b32 v90, 0
  v_mov_b32 v91, 0
  v_mov_b32 v92, 0
  v_mov_b32 v93, 0
  v_mov_b32 v94, 0
  v_mov_b32 v95, 0
  v_mov_b32 v96, 0
  v_mov_b32 v97, 0
  v_mov_b32 v98, 0
  v_mov_b32 v99, 0
  v_mov_b32 v100, 0
  v_mov_b32 v101, 0
  v_mov_b32 v102, 0
  v_mov_b32 v103, 0
  v_mul_u32_u24 v104, 528, v22
  v_lshl_add_u32 v104, v23, 4, v104
  v_add_u32 v104, s24, v104
  v_lshlrev_b32 v105, 3, v0
  s_lshl_b32 s25, s3, 3
  s_add_u32 s25, s25, 149760
  v_lshl_add_u32 v119, v0, 6, s25
  v_mov_b32 v125, 149504
  ds_read_b32 v131, v125 offset:96
  s_lshr_b32 s29, s3, 2
  s_lshl_b32 s29, s29, 3
  s_add_u32 s29, s29, s30
  s_lshl_b32 s29, s29, 2
  s_and_b32 s25, s3, 3
  s_add_u32 s29, s29, s25
  s_lshl_b32 s62, s29, 11
  s_and_b32 s25, s17, 3
  s_lshl_b32 s25, s25, 8
  s_add_u32 s62, s62, s25
  s_add_u32 s62, s62, 1048576
  s_mul_i32 s94, s29, 64
  s_lshl_b32 s25, s17, 3
  s_add_u32 s94, s94, s25
  s_add_u32 s94, s94, 262144
  s_lshl_b32 s95, s3, 5
  s_add_u32 s95, s95, s18
  s_mul_i32 s95, s95, 64
  s_add_u32 s95, s95, 262144
  v_mov_b32 v134, 0
  v_and_b32 v107, 31, v0
  v_lshrrev_b32 v108, 5, v0
  v_lshlrev_b32 v106, 4, v107
  v_and_b32 v114, 7, v0
  v_lshl_add_u32 v114, v114, 2, v23
  v_lshrrev_b32 v109, 3, v22
  v_lshl_add_u32 v114, v114, 1, v109
  v_lshlrev_b32 v114, 2, v114
  v_lshlrev_b32 v109, 2, v0
  v_and_b32 v110, 1, v0
  v_lshl_add_u32 v110, v110, 2, v23
  v_lshlrev_b32 v110, 3, v110
  v_and_b32 v112, 12, v109
  v_mul_u32_u24 v118, 49152, v108
  v_add_u32 v106, v118, v106
  s_mul_i32 s25, s3, 528
  v_add_u32 v106, s25, v106
  v_and_b32 v107, 7, v0
  v_lshlrev_b32 v108, 2, v108
  v_xor_b32 v108, v108, v107
  s_lshl_b32 s25, s3, 5
  s_add_u32 s25, s25, 150272
  v_lshl_add_u32 v108, v108, 2, s25
  s_lshl_b32 s74, s3, 5
  s_add_u32 s74, s74, s18
  s_lshl_b32 s74, s74, 11
  s_add_u32 s74, s74, 1048576
  v_lshlrev_b32 v111, 4, v0
  v_lshrrev_b32 v113, 2, v22
  v_lshl_add_u32 v113, v23, 3, v113
  v_lshlrev_b32 v113, 7, v113
  v_and_b32 v117, 3, v0
  v_lshl_add_u32 v113, v117, 3, v113
  s_and_b32 s25, s3, 3
  s_lshl_b32 s25, s25, 5
  s_add_u32 s25, s25, 131072
  v_add_u32 v113, s25, v113
  s_mul_i32 s25, s3, 272
  s_add_u32 s25, s25, 151552
  v_add_u32 v114, s25, v114
  v_mul_u32_u24 v116, 272, v22
  v_lshl_add_u32 v116, v23, 4, v116
  v_add_u32 v116, 151552, v116
  v_lshrrev_b32 v115, 2, v22
  v_lshlrev_b32 v115, 12, v115
  v_lshl_add_u32 v129, v117, 4, v115
  v_lshl_add_u32 v115, v23, 13, v129
  v_lshl_add_u32 v125, v117, 3, v125
  s_lshl_b32 s25, s3, 8
  s_add_u32 s25, s25, 155648
  v_lshl_add_u32 v128, v22, 4, s25
  s_lshl_b32 s29, s17, 17
  s_add_u32 s29, s29, 2097152
  s_lshl_b32 s25, s18, 7
  s_add_u32 s65, s29, s25
  s_lshl_b32 s25, s3, 14
  s_add_u32 s67, s65, s25
  s_add_u32 s67, s67, 64
  s_add_u32 s63, s67, 1048576
  s_lshl_b32 s25, s3, 15
  s_add_u32 s65, s65, s25
  s_add_u32 s64, s65, 1048576
  v_lshlrev_b32 v127, 10, v117
  v_lshl_add_u32 v127, v23, 1, v127
  v_lshrrev_b32 v118, 2, v0
  v_lshlrev_b32 v118, 7, v118
  v_lshl_add_u32 v117, v117, 4, v118
  s_lshr_b32 s66, s18, 1
  s_lshl_b32 s99, s66, 3
  s_lshl_b32 s66, s66, 13
  s_add_u32 s66, s66, s29
  s_and_b32 s25, s18, 1
  s_lshl_b32 s29, s25, 12
  s_add_u32 s66, s66, s29
  s_add_u32 s98, s66, 64
  s_lshl_b32 s25, s25, 12
  s_add_u32 s99, s99, s25
  s_lshl_b32 s25, s17, 7
  s_add_u32 s99, s99, s25
  s_waitcnt lgkmcnt(0)
  s_mov_b32 s25, 0x9e3779b1
  v_mul_lo_u32 v135, v131, s25
  v_lshrrev_b32 v112, v112, v135
  v_lshrrev_b32 v135, v22, v135
  s_add_u32 s97, s97, 1
  s_cmp_eq_u32 s97, 1
  s_cbranch_scc1 L_loop2
L_final:
  s_bitcmp1_b32 s27, 0
  s_cbranch_scc1 L_finv
  s_waitcnt vmcnt(0)
  v_add_u32 v40, s60, v7
  ds_read_b128 v[40:43], v40
  v_add_u32 v44, s60, v8
  ds_read_b128 v[44:47], v44
  v_add_u32 v48, s60, v9
  ds_read_b128 v[48:51], v48
  v_add_u32 v52, s60, v10
  ds_read_b128 v[52:55], v52
  s_andn2_b32 s25, s27, 127
  v_add_u32 v19, s25, v68
  s_waitcnt lgkmcnt(3)
  v_mfma_f32_16x16x32_bf16 v[56:59], v[40:43], v[24:27], 0
  s_waitcnt lgkmcnt(2)
  v_mfma_f32_16x16x32_bf16 v[56:59], v[44:47], v[28:31], v[56:59]
  s_waitcnt lgkmcnt(1)
  v_mfma_f32_16x16x32_bf16 v[56:59], v[48:51], v[32:35], v[56:59]
  s_waitcnt lgkmcnt(0)
  v_mfma_f32_16x16x32_bf16 v[56:59], v[52:55], v[36:39], v[56:59]
  s_nop 7
  v_cvt_pk_bf16_f32 v60, v56, v57
  v_cvt_pk_bf16_f32 v61, v58, v59
  v_lshlrev_b32 v56, 16, v60
  v_and_b32 v57, 0xffff0000, v60
  v_lshlrev_b32 v58, 16, v61
  v_and_b32 v59, 0xffff0000, v61
  v_mul_f32 v56, s58, v56
  v_mul_f32 v57, s58, v57
  v_mul_f32 v58, s58, v58
  v_mul_f32 v59, s58, v59
  v_cvt_pk_bf16_f32 v66, v56, v57
  v_cvt_pk_bf16_f32 v67, v58, v59
  s_mov_b64 exec, s[68:69]
  ds_write_b64 v19, v[66:67]
  s_mov_b64 exec, -1
  s_branch L_fin2
L_espin:
  s_sub_u32 s76, s76, 1
  s_cmp_le_i32 s76, 0
  s_cbranch_scc1 L_term
  ds_read_b32 v62, v70
  s_waitcnt lgkmcnt(0)
  s_branch L_eretry
L_special:
  s_bitcmp1_b32 s23, 0
  s_cbranch_scc0 L_term
  v_mov_b32 v69, 149648
  s_mov_b32 s78, 152696
  s_mov_b64 exec, 1
  ds_add_rtn_u32 v62, v69, v63
  s_mov_b64 exec, -1
  s_waitcnt lgkmcnt(0)
  v_readfirstlane_b32 s25, v62
  s_and_b32 s75, s25, 1
  s_lshr_b32 s25, s25, 1
  s_lshl2_add_u32 s25, s25, s78
  v_mov_b32 v70, s25
  s_branch L_espin
L_term:
  s_or_b32 s97, s97, 2
  v_mov_b32 v69, 149652
  s_branch L_proc
L_finv:
  s_andn2_b32 s25, s27, 127
  v_add_u32 v19, s25, v68
  ds_read_b64 v[66:67], v19
  s_waitcnt lgkmcnt(0)
L_sr3:
  v_cmp_eq_u32 vcc, s79, v66
  s_cbranch_vccnz L_ss3
  v_cmp_eq_u32 vcc, s79, v67
  s_cbranch_vccnz L_ss3
L_sg3:
  v_lshlrev_b32 v56, 16, v66
  v_and_b32 v57, 0xffff0000, v66
  v_lshlrev_b32 v58, 16, v67
  v_and_b32 v59, 0xffff0000, v67
  v_max3_f32 v60, v56, v57, v58
  v_max3_f32 v60, v60, v59, v20
  v_cmp_gt_f32 vcc, v60, v20
  s_cbranch_vccz L_nr3
  v_mov_b32 v61, v60
  s_nop 1
  v_permlane16_swap_b32 v60, v61
  v_max_f32 v60, v60, v61
  v_mov_b32 v61, v60
  s_nop 1
  v_permlane32_swap_b32 v60, v61
  v_max_f32 v60, v60, v61
  v_sub_f32 v61, v20, v60
  v_mul_f32 v61, s59, v61
  v_exp_f32 v61, v61
  v_mov_b32 v20, v60
  v_mul_f32 v65, s31, v60
  v_mul_f32 v21, v21, v61
  v_mul_f32 v72, v72, v61
  v_mul_f32 v73, v73, v61
  v_mul_f32 v74, v74, v61
  v_mul_f32 v75, v75, v61
  v_mul_f32 v76, v76, v61
  v_mul_f32 v77, v77, v61
  v_mul_f32 v78, v78, v61
  v_mul_f32 v79, v79, v61
  v_mul_f32 v80, v80, v61
  v_mul_f32 v81, v81, v61
  v_mul_f32 v82, v82, v61
  v_mul_f32 v83, v83, v61
  v_mul_f32 v84, v84, v61
  v_mul_f32 v85, v85, v61
  v_mul_f32 v86, v86, v61
  v_mul_f32 v87, v87, v61
  v_mul_f32 v88, v88, v61
  v_mul_f32 v89, v89, v61
  v_mul_f32 v90, v90, v61
  v_mul_f32 v91, v91, v61
  v_mul_f32 v92, v92, v61
  v_mul_f32 v93, v93, v61
  v_mul_f32 v94, v94, v61
  v_mul_f32 v95, v95, v61
  v_mul_f32 v96, v96, v61
  v_mul_f32 v97, v97, v61
  v_mul_f32 v98, v98, v61
  v_mul_f32 v99, v99, v61
  v_mul_f32 v100, v100, v61
  v_mul_f32 v101, v101, v61
  v_mul_f32 v102, v102, v61
  v_mul_f32 v103, v103, v61
L_nr3:
  v_fma_f32 v56, v56, s59, v65
  v_fma_f32 v57, v57, s59, v65
  v_fma_f32 v58, v58, s59, v65
  v_fma_f32 v59, v59, s59, v65
  v_exp_f32 v56, v56
  v_exp_f32 v57, v57
  v_exp_f32 v58, v58
  v_exp_f32 v59, v59
  v_cvt_pk_bf16_f32 v66, v56, v57
  v_cvt_pk_bf16_f32 v67, v58, v59
  v_add_f32 v60, v56, v57
  v_add_f32 v61, v58, v59
  v_add_f32 v60, v60, v61
  v_add_f32 v21, v21, v60
L_fin2:
  v_mov_b32 v61, v21
  s_nop 1
  v_permlane16_swap_b32 v21, v61
  v_add_f32 v21, v21, v61
  v_mov_b32 v61, v21
  s_nop 1
  v_permlane32_swap_b32 v21, v61
  v_add_f32 v21, v21, v61
  s_mov_b32 s76, 1048576
  s_mov_b64 exec, 0xff
  ds_write_b64 v119, v[20:21]
  s_mov_b64 exec, -1
  v_add_u32 v40, s60, v11
  v_add_u32 v42, s60, v12
  v_add_u32 v44, s60, v13
  v_add_u32 v46, s60, v14
  v_add_u32 v48, s60, v15
  v_add_u32 v50, s60, v16
  v_add_u32 v52, s60, v17
  v_add_u32 v54, s60, v18
  s_mov_b32 s68, 0x00010001
  s_mov_b32 s69, 0x00010001
  s_mov_b32 s76, 65536
  s_waitcnt vmcnt(0)
  s_bitcmp1_b32 s27, 0
  s_cbranch_scc0 L_fin3
  ds_read_b64_tr_b16 v[40:41], v40
  ds_read_b64_tr_b16 v[42:43], v42
  ds_read_b64_tr_b16 v[44:45], v44
  ds_read_b64_tr_b16 v[46:47], v46
  ds_read_b64_tr_b16 v[48:49], v48
  ds_read_b64_tr_b16 v[50:51], v50
  ds_read_b64_tr_b16 v[52:53], v52
  ds_read_b64_tr_b16 v[54:55], v54
  s_waitcnt lgkmcnt(7)
  v_mfma_f32_16x16x16_bf16 v[72:75], v[40:41], v[66:67], v[72:75]
  s_waitcnt lgkmcnt(6)
  v_mfma_f32_16x16x16_bf16 v[76:79], v[42:43], v[66:67], v[76:79]
  s_waitcnt lgkmcnt(5)
  v_mfma_f32_16x16x16_bf16 v[80:83], v[44:45], v[66:67], v[80:83]
  s_waitcnt lgkmcnt(4)
  v_mfma_f32_16x16x16_bf16 v[84:87], v[46:47], v[66:67], v[84:87]
  s_waitcnt lgkmcnt(3)
  v_mfma_f32_16x16x16_bf16 v[88:91], v[48:49], v[66:67], v[88:91]
  s_waitcnt lgkmcnt(2)
  v_mfma_f32_16x16x16_bf16 v[92:95], v[50:51], v[66:67], v[92:95]
  s_waitcnt lgkmcnt(1)
  v_mfma_f32_16x16x16_bf16 v[96:99], v[52:53], v[66:67], v[96:99]
  s_waitcnt lgkmcnt(0)
  v_mfma_f32_16x16x16_bf16 v[100:103], v[54:55], v[66:67], v[100:103]
L_fin3:
  s_mov_b32 exec_lo, 0x000f000f
  s_mov_b32 exec_hi, 0x000f000f
  ds_write_b128 v104, v[72:75] offset:0
  ds_write_b128 v104, v[76:79] offset:64
  ds_write_b128 v104, v[80:83] offset:128
  ds_write_b128 v104, v[84:87] offset:192
  ds_write_b128 v104, v[88:91] offset:256
  s_nop 0
  ds_write_b128 v104, v[92:95] offset:320
  s_nop 0
  ds_write_b128 v104, v[96:99] offset:384
  s_nop 0
  ds_write_b128 v104, v[100:103] offset:448
  s_mov_b64 exec, -1
  v_readfirstlane_b32 s30, v131
  s_mov_b64 s[22:23], -1
  s_movk_i32 s28, 0xff
  s_mov_b32 s29, -1
  s_mov_b32 s31, s30
  s_cmp_gt_u32 s3, 3
  s_waitcnt lgkmcnt(0)
  s_barrier
  s_cbranch_scc1 L_nocmb0
  ds_read_b32 v136, v108
  ds_read_b128 v[88:91], v106 offset:0
  ds_read_b128 v[92:95], v106 offset:12288
  ds_read_b128 v[96:99], v106 offset:24576
  ds_read_b128 v[100:103], v106 offset:36864
  s_waitcnt lgkmcnt(3)
  v_mul_f32_dpp v56, v136, v88 row_newbcast:0 row_mask:0xf bank_mask:0xf
  v_mul_f32_dpp v57, v136, v89 row_newbcast:0 row_mask:0xf bank_mask:0xf
  v_mul_f32_dpp v58, v136, v90 row_newbcast:0 row_mask:0xf bank_mask:0xf
  v_mul_f32_dpp v59, v136, v91 row_newbcast:0 row_mask:0xf bank_mask:0xf
  s_waitcnt lgkmcnt(2)
  v_fmac_f32_dpp v56, v136, v92 row_newbcast:1 row_mask:0xf bank_mask:0xf
  v_fmac_f32_dpp v57, v136, v93 row_newbcast:1 row_mask:0xf bank_mask:0xf
  v_fmac_f32_dpp v58, v136, v94 row_newbcast:1 row_mask:0xf bank_mask:0xf
  v_fmac_f32_dpp v59, v136, v95 row_newbcast:1 row_mask:0xf bank_mask:0xf
  s_waitcnt lgkmcnt(1)
  v_fmac_f32_dpp v56, v136, v96 row_newbcast:2 row_mask:0xf bank_mask:0xf
  v_fmac_f32_dpp v57, v136, v97 row_newbcast:2 row_mask:0xf bank_mask:0xf
  v_fmac_f32_dpp v58, v136, v98 row_newbcast:2 row_mask:0xf bank_mask:0xf
  v_fmac_f32_dpp v59, v136, v99 row_newbcast:2 row_mask:0xf bank_mask:0xf
  s_waitcnt lgkmcnt(0)
  s_load_dwordx8 s[4:11], s[56:57], s95 glc
  v_fmac_f32_dpp v56, v136, v100 row_newbcast:3 row_mask:0xf bank_mask:0xf
  v_fmac_f32_dpp v57, v136, v101 row_newbcast:3 row_mask:0xf bank_mask:0xf
  v_fmac_f32_dpp v58, v136, v102 row_newbcast:3 row_mask:0xf bank_mask:0xf
  v_fmac_f32_dpp v59, v136, v103 row_newbcast:3 row_mask:0xf bank_mask:0xf
  s_nop 0
  v_permlane32_swap_b32 v56, v58
  v_permlane32_swap_b32 v57, v59
  v_add_f32 v56, v56, v58
  v_add_f32 v57, v57, v59
  v_cvt_pk_f16_f32 v56, v56, v57
  v_bfi_b32 v56, s68, v135, v56
  buffer_store_dword v56, v109, s[12:15], s62 offen sc1
  s_branch L_nocmb
L_nocmb0:
  s_load_dwordx8 s[4:11], s[56:57], s95 glc
L_nocmb:
  ds_read_b32 v60, v64 offset:12
  ds_read_b64 v[132:133], v125 offset:64
  s_waitcnt lgkmcnt(0)
  s_xor_b64 s[26:27], s[4:5], s[30:31]
  s_and_b64 s[26:27], s[26:27], s[28:29]
  s_cselect_b32 s24, 0, 0xffff
  s_xor_b64 s[26:27], s[6:7], s[30:31]
  s_and_b64 s[26:27], s[26:27], s[28:29]
  s_cselect_b32 s25, 0, 0xffff0000
  s_or_b32 s24, s24, s25
  s_xor_b64 s[26:27], s[8:9], s[30:31]
  s_and_b64 s[26:27], s[26:27], s[28:29]
  s_cselect_b32 s25, 0, 0xffff
  s_xor_b64 s[26:27], s[10:11], s[30:31]
  s_and_b64 s[26:27], s[26:27], s[28:29]
  s_cselect_b32 s33, 0, 0xffff0000
  s_or_b32 s25, s25, s33
  s_and_b64 exec, s[24:25], s[22:23]
  s_cbranch_scc0 L_so1
  s_andn2_b64 s[22:23], s[22:23], exec
  buffer_load_dwordx4 v[72:75], v111, s[12:15], s74 offen sc1
L_so1:
  s_mov_b64 exec, 0xffff
  v_readfirstlane_b32 s63, v60
  s_mov_b64 exec, -1
  s_cmp_eq_u64 s[22:23], 0
  s_cbranch_scc1 L_f1done
L_f1:
  s_load_dwordx8 s[4:11], s[56:57], s95 glc
  s_sub_u32 s76, s76, 1
  s_waitcnt lgkmcnt(0)
  s_xor_b64 s[26:27], s[4:5], s[30:31]
  s_and_b64 s[26:27], s[26:27], s[28:29]
  s_cselect_b32 s24, 0, 0xffff
  s_xor_b64 s[26:27], s[6:7], s[30:31]
  s_and_b64 s[26:27], s[26:27], s[28:29]
  s_cselect_b32 s25, 0, 0xffff0000
  s_or_b32 s24, s24, s25
  s_xor_b64 s[26:27], s[8:9], s[30:31]
  s_and_b64 s[26:27], s[26:27], s[28:29]
  s_cselect_b32 s25, 0, 0xffff
  s_xor_b64 s[26:27], s[10:11], s[30:31]
  s_and_b64 s[26:27], s[26:27], s[28:29]
  s_cselect_b32 s33, 0, 0xffff0000
  s_or_b32 s25, s25, s33
  s_and_b64 exec, s[24:25], s[22:23]
  s_cbranch_scc0 L_f1n
  s_andn2_b64 s[22:23], s[22:23], exec
  s_cselect_b64 exec, exec, -1
  buffer_load_dwordx4 v[72:75], v111, s[12:15], s74 offen sc1
  s_cbranch_scc0 L_f1done
L_f1n:
  s_cmp_eq_u32 s76, 0
  s_cbranch_scc1 L_f1done
  s_sleep 1
  s_branch L_f1
L_f1done:
  s_mov_b64 exec, -1
  v_writelane_b32 v28, s4, 0
  v_writelane_b32 v28, s6, 16
  v_writelane_b32 v28, s8, 32
  v_writelane_b32 v28, s10, 48
  v_mov_b32 v60, v28
  v_mov_b32 v61, v60
  s_nop 1
  v_permlane16_swap_b32 v60, v61
  v_max_f32 v60, v60, v61
  v_mov_b32 v61, v60
  s_nop 1
  v_permlane32_swap_b32 v60, v61
  v_max_f32 v60, v60, v61
  v_sub_f32 v28, v28, v60
  v_exp_f32 v28, v28
  s_nop 0
  v_mov_b32 v60, v28
  v_mov_b32 v61, v60
  s_nop 1
  v_permlane16_swap_b32 v60, v61
  v_add_f32 v60, v60, v61
  v_mov_b32 v61, v60
  s_nop 1
  v_permlane32_swap_b32 v60, v61
  v_add_f32 v60, v60, v61
  v_rcp_f32 v60, v60
  s_nop 0
  v_mul_f32 v28, v28, v60
  v_lshrrev_b32 v49, 1, v112
  v_lshrrev_b32 v50, 2, v112
  v_lshrrev_b32 v51, 3, v112
  v_mov_b32_dpp v24, v28 row_newbcast:0 row_mask:0xf bank_mask:0xf
L_pchk:
  s_mov_b64 exec, -1
  s_waitcnt vmcnt(0)
  ds_read_b32 v60, v64 offset:16
  v_fma_mix_f32 v32, v24, v72, 0 op_sel:[0,0,0] op_sel_hi:[0,1,0]
  v_fma_mix_f32 v33, v24, v72, 0 op_sel:[0,1,0] op_sel_hi:[0,1,0]
  v_fma_mix_f32 v34, v24, v73, 0 op_sel:[0,0,0] op_sel_hi:[0,1,0]
  v_fma_mix_f32 v35, v24, v73, 0 op_sel:[0,1,0] op_sel_hi:[0,1,0]
  v_fma_mix_f32 v36, v24, v74, 0 op_sel:[0,0,0] op_sel_hi:[0,1,0]
  v_fma_mix_f32 v37, v24, v74, 0 op_sel:[0,1,0] op_sel_hi:[0,1,0]
  v_fma_mix_f32 v38, v24, v75, 0 op_sel:[0,0,0] op_sel_hi:[0,1,0]
  v_fma_mix_f32 v39, v24, v75, 0 op_sel:[0,1,0] op_sel_hi:[0,1,0]
  v_permlane32_swap_b32 v32, v36
  v_permlane32_swap_b32 v33, v37
  v_permlane32_swap_b32 v34, v38
  v_permlane32_swap_b32 v35, v39
  v_add_f32 v32, v32, v36
  v_add_f32 v33, v33, v37
  v_add_f32 v34, v34, v38
  v_add_f32 v35, v35, v39
  s_nop 0
  v_permlane16_swap_b32 v32, v34
  v_permlane16_swap_b32 v33, v35
  v_add_f32 v32, v32, v34
  v_add_f32 v33, v33, v35
  v_cvt_pk_bf16_f32 v32, v32, v33
  ds_write_b32 v114, v32
  v_xor_b32 v40, v72, v112
  v_xor_b32 v41, v73, v49
  v_xor_b32 v42, v74, v50
  v_xor_b32 v43, v75, v51
  v_or3_b32 v40, v40, v41, v42
  v_or_b32 v40, v40, v43
  v_and_b32 v40, s68, v40
  v_cmp_ne_u32 vcc, 0, v40
  s_cbranch_vccnz L_prep
L_pdone:
  s_cmp_lg_u32 s3, 4
  s_cbranch_scc1 L_nobp
  buffer_load_dwordx4 v[144:147], v117, s[12:15], s98 offen offset:0 sc1
  buffer_load_dwordx4 v[148:151], v117, s[12:15], s98 offen offset:2048 sc1
L_nobp:
  s_waitcnt lgkmcnt(1)
  v_readfirstlane_b32 s33, v60
  s_cmp_gt_u32 s3, 3
  s_cbranch_scc1 L_nopre
  s_cmp_eq_u32 s33, 0
  s_cbranch_scc1 L_nopre
  ds_read_b64_tr_b16 v[152:153], v113 offset:0
  ds_read_b64_tr_b16 v[154:155], v113 offset:512
  ds_read_b64_tr_b16 v[156:157], v113 offset:4096
  ds_read_b64_tr_b16 v[158:159], v113 offset:4608
  ds_read_b64_tr_b16 v[160:161], v113 offset:8192
  ds_read_b64_tr_b16 v[162:163], v113 offset:8704
  ds_read_b64_tr_b16 v[164:165], v113 offset:12288
  ds_read_b64_tr_b16 v[166:167], v113 offset:12800
  s_mov_b64 exec, s[70:71]
  s_waitcnt lgkmcnt(8)
  s_barrier
  ds_read_b128 v[72:75], v116 offset:0
  ds_read_b128 v[76:79], v116 offset:64
  ds_read_b128 v[80:83], v116 offset:128
  ds_read_b128 v[84:87], v116 offset:192
  s_mov_b64 exec, -1
  s_waitcnt lgkmcnt(3)
  v_mfma_f32_16x16x32_bf16 v[88:91], v[152:155], v[72:75], 0
  s_waitcnt lgkmcnt(2)
  v_mfma_f32_16x16x32_bf16 v[88:91], v[156:159], v[76:79], v[88:91]
  s_waitcnt lgkmcnt(1)
  v_mfma_f32_16x16x32_bf16 v[88:91], v[160:163], v[80:83], v[88:91]
  s_waitcnt lgkmcnt(0)
  v_mfma_f32_16x16x32_bf16 v[88:91], v[164:167], v[84:87], v[88:91]
L_mmd:
  s_mov_b64 exec, s[70:71]
  s_nop 6
  v_perm_b32 v88, v88, v131, s42
  v_perm_b32 v89, v89, v131, s43
  v_perm_b32 v90, v90, v131, s44
  v_perm_b32 v91, v91, v131, s45
  s_cmp_eq_u32 s63, 1
  s_cbranch_scc1 L_asn
  buffer_store_dwordx4 v[88:91], v115, s[12:15], s65 offen sc1
  s_branch L_asd
L_asn:
  buffer_store_dwordx4 v[88:91], v115, s[12:15], s65 offen
L_asd:
  s_mov_b64 exec, -1
L_nomm:
  s_cmp_lg_u32 s3, 4
  s_cbranch_scc1 L_end
  s_mov_b32 s76, 65536
  s_movk_i32 s23, 160
  s_mov_b32 s60, s52
  s_mov_b32 s61, s53
  s_mov_b32 s62, 0x2000
  s_mov_b32 s63, 0x00020000
L_bchk:
  s_mov_b64 exec, -1
  s_sub_u32 s76, s76, 1
  s_waitcnt vmcnt(0)
  v_perm_b32 v40, v145, v144, s46
  v_perm_b32 v41, v147, v146, s47
  v_perm_b32 v42, v149, v148, s46
  v_perm_b32 v43, v151, v150, s47
  v_xor_b32 v40, v40, v131
  v_xor_b32 v42, v42, v131
  v_xor_b32 v40, v40, v41
  v_xor_b32 v42, v42, v43
  v_or_b32 v40, v40, v42
  v_cmp_ne_u32 vcc, 0, v40
  s_cbranch_vccz L_bdone
  s_cmp_eq_u32 s76, 0
  s_cbranch_scc1 L_bdone
  s_mov_b64 exec, vcc
  s_sleep 1
  buffer_load_dwordx4 v[144:147], v117, s[12:15], s98 offen offset:0 sc1
  buffer_load_dwordx4 v[148:151], v117, s[12:15], s98 offen offset:2048 sc1
  s_branch L_bchk
L_bdone:
  v_add_f32 v52, v144, v148
  v_add_f32 v53, v145, v149
  v_add_f32 v54, v146, v150
  v_add_f32 v55, v147, v151
  s_nop 0
  v_permlane32_swap_b32 v52, v54
  v_permlane32_swap_b32 v53, v55
  v_add_f32 v52, v52, v54
  v_add_f32 v53, v53, v55
  s_nop 1
  v_permlane16_swap_b32 v52, v53
  v_add_f32 v52, v52, v53
  s_nop 1
  v_add_f32_dpp v52, v52, v52 row_ror:8 row_mask:0xf bank_mask:0xf
  s_nop 1
  v_add_f32_dpp v52, v52, v52 row_ror:4 row_mask:0xf bank_mask:0xf
  v_cvt_pk_bf16_f32 v52, v52, v52
  v_lshlrev_b32 v52, 16, v52
  v_mul_f32 v52, v133, v52
  v_cvt_pk_bf16_f32 v52, v52, v52
  v_lshlrev_b32 v52, 16, v52
L_apoll:
  buffer_load_dwordx4 v[136:139], v117, s[12:15], s66 offen offset:0 sc1
  buffer_load_dwordx4 v[140:143], v117, s[12:15], s66 offen offset:2048 sc1
  s_mov_b64 exec, -1
  s_sub_u32 s76, s76, 1
  s_waitcnt vmcnt(0)
  v_perm_b32 v40, v137, v136, s46
  v_perm_b32 v41, v139, v138, s47
  v_perm_b32 v42, v141, v140, s46
  v_perm_b32 v43, v143, v142, s47
  v_xor_b32 v40, v40, v131
  v_xor_b32 v42, v42, v131
  v_xor_b32 v40, v40, v41
  v_xor_b32 v42, v42, v43
  v_or_b32 v40, v40, v42
  v_cmp_ne_u32 vcc, 0, v40
  s_cbranch_vccz L_adone
  s_mov_b64 exec, vcc
  s_cmp_lg_u32 s76, 0
  s_cbranch_scc1 L_apoll
  s_mov_b64 exec, -1
L_adone:
  v_add_f32 v48, v136, v140
  v_add_f32 v49, v137, v141
  v_add_f32 v50, v138, v142
  v_add_f32 v51, v139, v143
  s_nop 0
  v_permlane32_swap_b32 v48, v50
  v_permlane32_swap_b32 v49, v51
  v_add_f32 v48, v48, v50
  v_add_f32 v49, v49, v51
  s_nop 1
  v_permlane16_swap_b32 v48, v49
  v_add_f32 v48, v48, v49
  s_nop 1
  v_add_f32_dpp v48, v48, v48 row_ror:8 row_mask:0xf bank_mask:0xf
  s_nop 1
  v_add_f32_dpp v48, v48, v48 row_ror:4 row_mask:0xf bank_mask:0xf
  v_cvt_pk_bf16_f32 v48, v48, v48
  v_lshlrev_b32 v48, 16, v48
  v_mul_f32 v48, v132, v48
  v_cvt_pk_bf16_f32 v48, v48, v48
  v_lshlrev_b32 v48, 16, v48
  v_add_f32 v48, v48, v52
  v_cvt_pk_bf16_f32 v48, v48, v48
  s_mov_b32 exec_lo, 983055
  s_mov_b32 exec_hi, 983055
  buffer_store_short v48, v127, s[60:63], s99 offen
  s_mov_b64 exec, -1
  s_endpgm
L_ss2:
  s_sub_u32 s76, s76, 1
  s_cmp_le_i32 s76, 0
  s_cbranch_scc1 L_sg2
  ds_read_b64 v[66:67], v19
  s_waitcnt lgkmcnt(0)
  s_branch L_sr2
L_pv1:
  s_andn2_b32 s25, s27, 127
  v_add_u32 v19, s25, v68
  ds_read_b64 v[66:67], v19
  v_add_u32 v40, s60, v11
  ds_read_b64_tr_b16 v[40:41], v40
  v_add_u32 v42, s60, v12
  ds_read_b64_tr_b16 v[42:43], v42
  v_add_u32 v44, s60, v13
  ds_read_b64_tr_b16 v[44:45], v44
  v_add_u32 v46, s60, v14
  ds_read_b64_tr_b16 v[46:47], v46
  v_add_u32 v48, s60, v15
  ds_read_b64_tr_b16 v[48:49], v48
  v_add_u32 v50, s60, v16
  ds_read_b64_tr_b16 v[50:51], v50
  v_add_u32 v52, s60, v17
  ds_read_b64_tr_b16 v[52:53], v52
  v_add_u32 v54, s60, v18
  ds_read_b64_tr_b16 v[54:55], v54
  s_waitcnt lgkmcnt(8)
  v_readfirstlane_b32 s25, v62
  s_and_b32 s75, s25, 1
  s_lshr_b32 s25, s25, 1
  s_lshl2_add_u32 s25, s25, s78
  v_mov_b32 v70, s25
L_sr2:
  v_cmp_eq_u32 vcc, s79, v66
  s_cbranch_vccnz L_ss2
  v_cmp_eq_u32 vcc, s79, v67
  s_cbranch_vccnz L_ss2
L_sg2:
  v_lshlrev_b32 v56, 16, v66
  v_and_b32 v57, 0xffff0000, v66
  v_lshlrev_b32 v58, 16, v67
  v_and_b32 v59, 0xffff0000, v67
  v_max3_f32 v60, v56, v57, v58
  v_max3_f32 v60, v60, v59, v20
  v_cmp_gt_f32 vcc, v60, v20
  s_cbranch_vccz L_nr2
  v_mov_b32 v61, v60
  s_nop 1
  v_permlane16_swap_b32 v60, v61
  v_max_f32 v60, v60, v61
  v_mov_b32 v61, v60
  s_nop 1
  v_permlane32_swap_b32 v60, v61
  v_max_f32 v60, v60, v61
  v_sub_f32 v61, v20, v60
  v_mul_f32 v61, s59, v61
  v_exp_f32 v61, v61
  v_mov_b32 v20, v60
  v_mul_f32 v65, s31, v60
  v_mul_f32 v21, v21, v61
  v_mul_f32 v72, v72, v61
  v_mul_f32 v73, v73, v61
  v_mul_f32 v74, v74, v61
  v_mul_f32 v75, v75, v61
  v_mul_f32 v76, v76, v61
  v_mul_f32 v77, v77, v61
  v_mul_f32 v78, v78, v61
  v_mul_f32 v79, v79, v61
  v_mul_f32 v80, v80, v61
  v_mul_f32 v81, v81, v61
  v_mul_f32 v82, v82, v61
  v_mul_f32 v83, v83, v61
  v_mul_f32 v84, v84, v61
  v_mul_f32 v85, v85, v61
  v_mul_f32 v86, v86, v61
  v_mul_f32 v87, v87, v61
  v_mul_f32 v88, v88, v61
  v_mul_f32 v89, v89, v61
  v_mul_f32 v90, v90, v61
  v_mul_f32 v91, v91, v61
  v_mul_f32 v92, v92, v61
  v_mul_f32 v93, v93, v61
  v_mul_f32 v94, v94, v61
  v_mul_f32 v95, v95, v61
  v_mul_f32 v96, v96, v61
  v_mul_f32 v97, v97, v61
  v_mul_f32 v98, v98, v61
  v_mul_f32 v99, v99, v61
  v_mul_f32 v100, v100, v61
  v_mul_f32 v101, v101, v61
  v_mul_f32 v102, v102, v61
  v_mul_f32 v103, v103, v61
L_nr2:
  v_fma_f32 v56, v56, s59, v65
  v_fma_f32 v57, v57, s59, v65
  v_fma_f32 v58, v58, s59, v65
  v_fma_f32 v59, v59, s59, v65
  v_exp_f32 v56, v56
  v_exp_f32 v57, v57
  v_exp_f32 v58, v58
  v_exp_f32 v59, v59
  v_cvt_pk_bf16_f32 v66, v56, v57
  v_cvt_pk_bf16_f32 v67, v58, v59
  v_add_f32 v60, v56, v57
  v_add_f32 v61, v58, v59
  v_add_f32 v60, v60, v61
  v_add_f32 v21, v21, v60
  s_waitcnt lgkmcnt(0)
  v_mfma_f32_16x16x16_bf16 v[72:75], v[40:41], v[66:67], v[72:75]
  v_mfma_f32_16x16x16_bf16 v[76:79], v[42:43], v[66:67], v[76:79]
  v_mfma_f32_16x16x16_bf16 v[80:83], v[44:45], v[66:67], v[80:83]
  v_mfma_f32_16x16x16_bf16 v[84:87], v[46:47], v[66:67], v[84:87]
  v_mfma_f32_16x16x16_bf16 v[88:91], v[48:49], v[66:67], v[88:91]
  v_mfma_f32_16x16x16_bf16 v[92:95], v[50:51], v[66:67], v[92:95]
  v_mfma_f32_16x16x16_bf16 v[96:99], v[52:53], v[66:67], v[96:99]
  v_mfma_f32_16x16x16_bf16 v[100:103], v[54:55], v[66:67], v[100:103]
  s_branch L_pd
L_ss3:
  s_sub_u32 s76, s76, 1
  s_cmp_le_i32 s76, 0
  s_cbranch_scc1 L_sg3
  ds_read_b64 v[66:67], v19
  s_waitcnt lgkmcnt(0)
  s_branch L_sr3
L_nopre:
  s_cmp_gt_u32 s3, 3
  s_waitcnt lgkmcnt(0)
  s_barrier
  s_cbranch_scc1 L_nomm
  ds_read_b128 v[72:75], v116 offset:0
  ds_read_b64_tr_b16 v[152:153], v113 offset:0
  ds_read_b64_tr_b16 v[154:155], v113 offset:512
  ds_read_b128 v[76:79], v116 offset:64
  ds_read_b64_tr_b16 v[156:157], v113 offset:4096
  ds_read_b64_tr_b16 v[158:159], v113 offset:4608
  ds_read_b128 v[80:83], v116 offset:128
  ds_read_b64_tr_b16 v[160:161], v113 offset:8192
  ds_read_b64_tr_b16 v[162:163], v113 offset:8704
  ds_read_b128 v[84:87], v116 offset:192
  ds_read_b64_tr_b16 v[164:165], v113 offset:12288
  ds_read_b64_tr_b16 v[166:167], v113 offset:12800
  s_waitcnt lgkmcnt(9)
  v_mfma_f32_16x16x32_bf16 v[88:91], v[152:155], v[72:75], 0
  s_waitcnt lgkmcnt(6)
  v_mfma_f32_16x16x32_bf16 v[88:91], v[156:159], v[76:79], v[88:91]
  s_waitcnt lgkmcnt(3)
  v_mfma_f32_16x16x32_bf16 v[88:91], v[160:163], v[80:83], v[88:91]
  s_waitcnt lgkmcnt(0)
  v_mfma_f32_16x16x32_bf16 v[88:91], v[164:167], v[84:87], v[88:91]
  s_branch L_mmd
L_prep:
  s_sub_u32 s76, s76, 1
  s_cmp_le_i32 s76, 0
  s_cbranch_scc1 L_pdone
  buffer_load_dwordx4 v[72:75], v111, s[12:15], s74 offen offset:0 sc1
  s_branch L_pchk
L_end:
  s_endpgm
.section .rodata,"a"
.p2align 6
.amdhsa_kernel gated_mix__gqa_block_cached__geglu_ffn__decode_kernel
  .amdhsa_next_free_vgpr 168
  .amdhsa_next_free_sgpr 102
  .amdhsa_accum_offset 168
  .amdhsa_group_segment_fixed_size 0
  .amdhsa_kernarg_size 104
  .amdhsa_user_sgpr_count 2
  .amdhsa_user_sgpr_kernarg_segment_ptr 1
  .amdhsa_system_sgpr_workgroup_id_x 1
.end_amdhsa_kernel
```
